```python
import torch

def _softmax(x, axis=-1):
    return torch.softmax(x, dim=axis)
def _gelu(x):
    return torch.nn.functional.gelu(x, approximate="tanh")
def _silu(x):
    return torch.nn.functional.silu(x)
def _sigmoid(x):
    return torch.sigmoid(x)
def _layernorm(x, axis=-1, eps=1e-5):
    m = x.mean(dim=axis, keepdim=True)
    v = x.var(dim=axis, keepdim=True, unbiased=False)
    return (x - m) / torch.sqrt(v + eps)
def _scatter_add(tgt, idx, src, axis=0):
    return tgt.clone().index_add_(axis, idx, src)
def _segment_sum(src, seg, n):
    out = torch.zeros((n,) + src.shape[1:], dtype=src.dtype)
    return out.index_add_(0, seg, src)
def _pad(x, pw):
    flat = tuple(v for pair in reversed(pw) for v in pair)
    return torch.nn.functional.pad(x, flat)

kernel_name = 'gated_mix__ssm_conv_s4__spectral_gfnet__prompt'

def setup_inputs():

    _w = (lambda a: (lambda t: t.to(torch.bfloat16) if t.is_floating_point() else t)(torch.as_tensor(a)))
    def _A_setup():
        B, L, D, N = 1, 2048, 512, 128
        A_re = -(lambda _x: torch.exp(torch.as_tensor(_x)))((lambda *s: torch.randn(*s, dtype=torch.bfloat16) * 3.2)(D, N))
        A_im = torch.pi * (lambda *s: torch.randn(*s, dtype=torch.bfloat16) * 0.05)(D, N)
        B_re = (lambda *s: torch.randn(*s, dtype=torch.bfloat16) * 0.1)(D, N)
        B_im = (lambda *s: torch.randn(*s, dtype=torch.bfloat16) * 0.1)(D, N)
        C_re = (lambda *s: torch.randn(*s, dtype=torch.bfloat16) * 0.1)(D, N)
        C_im = (lambda *s: torch.randn(*s, dtype=torch.bfloat16) * 0.1)(D, N)
        log_dt = (lambda *s: torch.randn(*s, dtype=torch.bfloat16) * 0.05)(D) * 0.5 - 4.0
        Dskip = (lambda *s: torch.randn(*s, dtype=torch.bfloat16) * 0.05)(D)
        return {
            "u": _w((lambda *s: torch.randn(*s, dtype=torch.bfloat16) * 0.05)(B, L, D)),
            "A_re": _w(A_re),
            "A_im": _w(A_im),
            "B_re": _w(B_re),
            "B_im": _w(B_im),
            "C_re": _w(C_re),
            "C_im": _w(C_im),
            "log_dt": _w(log_dt),
            "Dskip": _w(Dskip),
        }
    _A_in = _A_setup()

    def _B_setup():
        B, S, D = 1, 2048, 512
        Df = D // 2 + 1
        return {
            "x": _w((lambda *s: torch.randn(*s, dtype=torch.bfloat16) * 0.05)(B, S, D)),
            "w_r": _w((lambda *s: torch.randn(*s, dtype=torch.bfloat16) * 0.8)(S, Df) * 0.02),
            "w_i": _w((lambda *s: torch.randn(*s, dtype=torch.bfloat16) * 0.8)(S, Df) * 0.02),
        }
    _B_in = _B_setup()

    return {
        "A_u": _A_in["u"],
        "A_A_re": _A_in["A_re"],
        "A_A_im": _A_in["A_im"],
        "A_B_re": _A_in["B_re"],
        "A_B_im": _A_in["B_im"],
        "A_C_re": _A_in["C_re"],
        "A_C_im": _A_in["C_im"],
        "A_log_dt": _A_in["log_dt"],
        "A_Dskip": _A_in["Dskip"],
        "B_x": _B_in["x"],
        "B_w_r": _B_in["w_r"],
        "B_w_i": _B_in["w_i"],
        "gate_w": _w((lambda *s: torch.randn(*s, dtype=torch.bfloat16) * 0.05)(512) * 16.0),
    }

def reference(A_u, A_A_re, A_A_im, A_B_re, A_B_im, A_C_re, A_C_im, A_log_dt, A_Dskip, B_x, B_w_r, B_w_i, gate_w):
    def _A_ref(u, A_re, A_im, B_re, B_im, C_re, C_im, log_dt, Dskip):
        Bsz, L, D = u.shape
        dt = torch.exp(log_dt)[:, None]
        A = A_re + 1j * A_im
        Bc = B_re + 1j * B_im
        Cc = C_re + 1j * C_im
        logdA = dt * A
        dB = dt * Bc
        l = (lambda x, dt: x.to(dt))(torch.arange(L), A_re.dtype)
        P = torch.exp(logdA[:, :, None] * l[None, None, :])
        K = torch.einsum("dn,dnl,dn->dl", Cc, P, dB).real
        L2 = 2 * L
        Kp = _pad(K, ((0, 0), (0, L)))
        up = (lambda x, *d: x.permute(*d))(u, 0, 2, 1)
        up = _pad(up, ((0, 0), (0, 0), (0, L)))
        Kf = (lambda x, axes=(-2,-1): torch.fft.rfft2(x.float(), dim=axes))(Kp[:, None, :], axes=(-2, -1))
        Uf = (lambda x, axes=(-2,-1): torch.fft.rfft2(x.float(), dim=axes))(up[:, :, None, :], axes=(-2, -1))
        Yf = Uf * Kf[None, :, :, :]
        y = (lambda x, s, axes=(-2,-1): torch.fft.irfft2(x, s=s, dim=axes).to(torch.bfloat16))(Yf, (1, L2), axes=(-2, -1))[:, :, 0, :L]
        y = (lambda x, *d: x.permute(*d))(y, 0, 2, 1) + u * Dskip[None, None, :]
        return y

    def _B_ref(x, w_r, w_i):
        B, S, D = x.shape
        X = (lambda x, axes=(-2,-1): torch.fft.rfft2(x.float(), dim=axes))(x, axes=(-2, -1))
        W = w_r + 1j * w_i
        X = X * W
        y = (lambda x, s, axes=(-2,-1): torch.fft.irfft2(x, s=s, dim=axes).to(torch.bfloat16))(X, (S, D), axes=(-2, -1))
        return y

    x = A_u
    g = _sigmoid((x * gate_w).sum(-1, keepdims=True))
    a = _A_ref(x, A_A_re, A_A_im, A_B_re, A_B_im, A_C_re, A_C_im, A_log_dt, A_Dskip)
    b = _B_ref(x, B_w_r, B_w_i)
    return g * a + (1 - g) * b
```

```asm
; @launch grid=(512,1,1) block=(512,1,1) lds=77472
.amdgcn_target "amdgcn-amd-amdhsa--gfx950"
.text
.globl gated_mix__ssm_conv_s4__spectral_gfnet__prompt_kernel
.p2align 8
.type gated_mix__ssm_conv_s4__spectral_gfnet__prompt_kernel,@function
gated_mix__ssm_conv_s4__spectral_gfnet__prompt_kernel:
L_CODE:
    s_load_dwordx2 s[12:13], s[0:1], 120
    s_load_dwordx2 s[8:9], s[0:1], 0
    s_load_dwordx2 s[16:17], s[0:1], 96
    s_load_dwordx8 s[32:39], s[0:1], 8
    s_load_dwordx8 s[40:47], s[0:1], 40
    s_load_dwordx4 s[48:51], s[0:1], 80
    v_readfirstlane_b32 s3, v0
    v_and_b32 v1, 63, v0
    v_lshlrev_b32 v2, 4, v1
    s_lshr_b32 s3, s3, 6
    s_mov_b32 s14, 11534336
    s_mov_b32 s15, 0x20000
    v_lshrrev_b32 v4, 4, v1
    v_and_b32 v10, 15, v1
    s_and_b32 s97, s2, 0xff
    s_lshl_b32 s97, s97, 2
    s_cmpk_ge_u32 s2, 256
    s_cbranch_scc1 A_IN
    s_cmp_ge_u32 s3, 4
    s_cbranch_scc1 B_PF
    s_getpc_b64 s[20:21]
    s_add_u32 s20, s20, P1_TAB@rel32@lo+4100
    s_addc_u32 s21, s21, P1_TAB@rel32@hi+4108
    global_load_dwordx4 v[16:19], v2, s[20:21] offset:-4096
    global_load_dwordx4 v[20:23], v2, s[20:21] offset:-3072
    global_load_dwordx4 v[24:27], v2, s[20:21] offset:-2048
    global_load_dwordx4 v[28:31], v2, s[20:21] offset:-1024
    global_load_dwordx4 v[32:35], v2, s[20:21] offset:0
    global_load_dwordx4 v[36:39], v2, s[20:21] offset:1024
    global_load_dwordx4 v[40:43], v2, s[20:21] offset:2048
    global_load_dwordx4 v[44:47], v2, s[20:21] offset:3072
    s_mov_b32 s10, 2097152
    s_mov_b32 s11, 0x20000
    s_mov_b32 s18, 1024
    s_mov_b32 s19, 0x20000
    s_and_b32 s60, s2, 7
    s_lshr_b32 s61, s2, 3
    s_lshl_b32 s52, s60, 5
    s_add_u32 s52, s52, s61
    s_lshl_b32 s22, s52, 10
    s_lshl_b32 s23, s3, 19
    s_add_u32 s22, s22, s23
    s_lshl_b32 s24, s3, 11
    s_add_u32 s23, s22, 0x40000
    s_mov_b32 m0, s24
    s_waitcnt lgkmcnt(0)
    buffer_load_dwordx4 v2, s[8:11], s22 offen lds
    s_add_u32 m0, s24, 1024
    s_nop 0
    buffer_load_dwordx4 v2, s[8:11], s23 offen lds
    s_mov_b32 m0, 24640
    s_mov_b32 s4, 2359296
    buffer_load_dwordx4 v2, s[16:19], 0 offen lds
    s_load_dword s96, s[12:13], s4
    s_load_dwordx2 s[8:9], s[0:1], 104
    s_mov_b32 s32, s48
    s_mov_b32 s33, s49
    s_mov_b32 s36, s50
    s_mov_b32 s37, s51
    s_mov_b32 s34, 1052672
    s_mov_b32 s35, 0x20000
    s_mov_b32 s38, 1052672
    s_mov_b32 s39, 0x20000
    v_and_b32 v3, 7, v1
    v_lshl_add_u32 v3, s52, 3, v3
    v_mul_u32_u24 v13, 514, v3
    v_lshlrev_b32 v102, 1, v3
    buffer_load_ushort v100, v13, s[32:35], 0 offen offset:512
    buffer_load_ushort v101, v13, s[36:39], 0 offen offset:512
    v_bfe_u32 v3, v1, 1, 3
    v_lshl_add_u32 v5, v4, 9, s52
    v_mul_u32_u24 v5, v3, v5
    v_and_b32 v6, 1, v1
    v_lshl_add_u32 v5, v6, 9, v5
    v_lshl_add_u32 v6, v3, 8, v5
    v_cvt_f32_u32 v5, v5
    v_cvt_f32_u32 v6, v6
    v_mul_f32 v5, 0x3a000000, v5
    v_mul_f32 v6, 0x3a000000, v6
    v_cos_f32 v7, v5
    v_sin_f32 v5, v5
    v_cos_f32 v8, v6
    v_sin_f32 v6, v6
    v_cvt_pk_bf16_f32 v48, v7, v5
    v_cvt_pk_bf16_f32 v49, v8, v6
    v_and_b32 v103, 16, v1
    v_cmp_eq_u32 s[40:41], 0, v103
    v_cmp_eq_u32 vcc, 0, v10
    v_sub_u32 v11, 32, v10
    v_lshrrev_b32_e64 v103, 5, v1
    v_cndmask_b32 v11, v11, 16, vcc
    v_cndmask_b32 v11, v11, v10, s[40:41]
    v_lshl_add_u32 v103, v103, 7, v11
    s_mul_i32 s25, s3, 2064
    s_add_u32 s25, s25, 8192
    v_lshl_add_u32 v9, v103, 3, s25
    v_cndmask_b32 v50, 0, -1, vcc
    s_mov_b32 s26, 0xffff
    s_cmp_eq_u32 s3, 0
    s_cselect_b32 s26, s26, -1
    v_mov_b32 v11, s26
    v_cndmask_b32 v51, -1, v11, vcc
    v_mul_u32_u24 v14, 2064, v4
    s_lshl_b32 s26, s3, 9
    v_add_u32 v14, 8192, v14
    v_lshl_add_u32 v11, v10, 5, v14
    v_add_u32 v11, s26, v11
    v_lshlrev_b32 v12, 11, v4
    v_lshl_add_u32 v12, v10, 4, v12
    s_lshl_b32 s27, s52, 13
    s_lshl_b32 s26, s3, 8
    s_add_u32 s27, s27, s26
    v_lshl_add_u32 v13, v1, 3, s24
    v_lshlrev_b32 v15, 3, v1
    v_lshlrev_b32 v6, 3, v4
    s_lshl_b32 s53, s52, 5
    s_add_u32 s56, s53, 2097152
    s_waitcnt vmcnt(3) lgkmcnt(0)
    ds_read_b64_tr_b16 v[52:53], v13
    ds_read_b64_tr_b16 v[54:55], v13 offset:512
    ds_read_b64_tr_b16 v[56:57], v13 offset:1024
    ds_read_b64_tr_b16 v[58:59], v13 offset:1536
    s_waitcnt lgkmcnt(2)
    v_mfma_f32_16x16x32_bf16 v[60:63], v[52:55], v[16:19], 0
    v_mfma_f32_16x16x32_bf16 v[64:67], v[52:55], v[20:23], 0
    s_waitcnt lgkmcnt(0)
    v_mfma_f32_16x16x32_bf16 v[68:71], v[56:59], v[16:19], 0
    v_mfma_f32_16x16x32_bf16 v[72:75], v[56:59], v[20:23], 0
    s_add_u32 s96, s96, 1
    s_nop 2
    v_pk_mul_f32 v[76:77], v[60:61], v[24:25]
    v_pk_mul_f32 v[80:81], v[64:65], v[24:25]
    v_pk_mul_f32 v[78:79], v[62:63], v[26:27]
    v_pk_mul_f32 v[82:83], v[66:67], v[26:27]
    v_pk_fma_f32 v[76:77], v[64:65], v[28:29], v[76:77]
    v_pk_fma_f32 v[80:81], v[60:61], v[28:29], v[80:81] neg_lo:[1,0,0] neg_hi:[1,0,0]
    v_pk_fma_f32 v[78:79], v[66:67], v[30:31], v[78:79]
    v_pk_fma_f32 v[82:83], v[62:63], v[30:31], v[82:83] neg_lo:[1,0,0] neg_hi:[1,0,0]
    v_cvt_pk_bf16_f32 v16, v76, v80
    v_cvt_pk_bf16_f32 v17, v77, v81
    v_cvt_pk_bf16_f32 v18, v78, v82
    v_cvt_pk_bf16_f32 v19, v79, v83
    v_and_b32 v20, v50, v16
    v_and_b32 v21, v50, v17
    v_and_b32 v22, v50, v18
    v_and_b32 v23, v50, v19
    v_mfma_f32_16x16x32_bf16 v[60:63], v[32:35], v[16:19], 0
    v_mfma_f32_16x16x32_bf16 v[64:67], v[36:39], v[16:19], 0
    v_mfma_f32_16x16x32_bf16 v[60:63], v[40:43], v[20:23], v[60:63]
    v_mfma_f32_16x16x32_bf16 v[64:67], v[44:47], v[20:23], v[64:67]
    v_pk_mul_f32 v[76:77], v[68:69], v[24:25]
    v_pk_mul_f32 v[80:81], v[72:73], v[24:25]
    v_pk_mul_f32 v[78:79], v[70:71], v[26:27]
    v_pk_mul_f32 v[82:83], v[74:75], v[26:27]
    v_pk_fma_f32 v[76:77], v[72:73], v[28:29], v[76:77]
    v_pk_fma_f32 v[80:81], v[68:69], v[28:29], v[80:81] neg_lo:[1,0,0] neg_hi:[1,0,0]
    v_pk_fma_f32 v[78:79], v[74:75], v[30:31], v[78:79]
    v_pk_fma_f32 v[82:83], v[70:71], v[30:31], v[82:83] neg_lo:[1,0,0] neg_hi:[1,0,0]
    v_cvt_pk_bf16_f32 v84, v76, v80
    v_cvt_pk_bf16_f32 v85, v77, v81
    v_cvt_pk_bf16_f32 v86, v78, v82
    v_cvt_pk_bf16_f32 v87, v79, v83
    v_and_b32 v88, v50, v84
    v_and_b32 v89, v50, v85
    v_and_b32 v90, v50, v86
    v_and_b32 v91, v50, v87
    v_mfma_f32_16x16x32_bf16 v[68:71], v[32:35], v[84:87], 0
    v_mfma_f32_16x16x32_bf16 v[72:75], v[36:39], v[84:87], 0
    v_mfma_f32_16x16x32_bf16 v[68:71], v[40:43], v[88:91], v[68:71]
    v_mfma_f32_16x16x32_bf16 v[72:75], v[44:47], v[88:91], v[72:75]
    v_cvt_pk_bf16_f32 v92, v60, v64
    v_cvt_pk_bf16_f32 v94, v61, v65
    v_cvt_pk_bf16_f32 v96, v62, v66
    v_cvt_pk_bf16_f32 v98, v63, v67
    s_nop 3
    v_cvt_pk_bf16_f32 v93, v68, v72
    v_cvt_pk_bf16_f32 v95, v69, v73
    v_cvt_pk_bf16_f32 v97, v70, v74
    v_cvt_pk_bf16_f32 v99, v71, v75
    ds_write_b64 v9, v[92:93] offset:0
    ds_write_b64 v9, v[94:95] offset:256
    ds_write_b64 v9, v[96:97] offset:512
    ds_write_b64 v9, v[98:99] offset:768
    s_waitcnt vmcnt(2) lgkmcnt(0)
    s_barrier
    ds_read_b128 v[16:19], v11
    ds_read_b128 v[20:23], v11 offset:16
    ds_read_b64 v[24:25], v14
    ds_read_b64_tr_b16 v[36:37], v15 offset:24640
    ds_read_b64_tr_b16 v[38:39], v15 offset:25152
    s_waitcnt lgkmcnt(4)
    v_and_b32 v16, v51, v16
    v_and_b32 v17, v51, v17
    v_mfma_f32_16x16x16_bf16 v[64:67], v[48:49], v[18:19], 0
    s_waitcnt lgkmcnt(2)
    v_mfma_f32_16x16x16_bf16 v[60:63], v[48:49], v[16:17], 0
    v_lshrrev_b32 v24, 16, v24
    v_lshrrev_b32 v25, 16, v25
    v_mfma_f32_16x16x16_bf16 v[68:71], v[48:49], v[20:21], 0
    v_mfma_f32_16x16x16_bf16 v[72:75], v[48:49], v[22:23], 0
    v_mfma_f32_16x16x16_bf16 v[40:43], v[48:49], v[24:25], 0
    s_nop 0
    v_cvt_pk_bf16_f32 v77, v64, v65
    v_cvt_pk_bf16_f32 v81, v66, v67
    v_cvt_pk_bf16_f32 v76, v60, v61
    v_cvt_pk_bf16_f32 v80, v62, v63
    s_nop 0
    v_cvt_pk_bf16_f32 v78, v68, v69
    v_cvt_pk_bf16_f32 v82, v70, v71
    v_cvt_pk_bf16_f32 v79, v72, v73
    v_cvt_pk_bf16_f32 v83, v74, v75
    buffer_store_dwordx4 v[76:79], v12, s[12:15], s27 offen sc1
    buffer_store_dwordx4 v[80:83], v12, s[12:15], s27 offen offset:1024 sc1
    v_cvt_pk_bf16_f32 v44, v40, v41
    v_cvt_pk_bf16_f32 v45, v42, v43
    s_cmp_lg_u32 s3, 0
    s_cbranch_scc1 B_NONYQ
    s_mov_b32 exec_lo, 0x10001
    s_mov_b32 exec_hi, 0x10001
    buffer_store_dwordx2 v[44:45], v6, s[12:15], s56 offen sc1
    s_mov_b64 exec, 0xff
    s_mov_b32 s4, 2162688
    s_mov_b32 s5, 2166784
    s_waitcnt vmcnt(3)
    buffer_store_short v100, v102, s[12:15], s4 offen sc1
    buffer_store_short v101, v102, s[12:15], s5 offen sc1
    s_mov_b64 exec, -1
B_NONYQ:
    s_waitcnt lgkmcnt(0)
    v_dot2_f32_bf16 v60, v52, v36, 0
    v_dot2_f32_bf16 v61, v56, v36, 0
    v_dot2_f32_bf16 v60, v53, v37, v60
    v_dot2_f32_bf16 v61, v57, v37, v61
    v_dot2_f32_bf16 v60, v54, v38, v60
    v_dot2_f32_bf16 v61, v58, v38, v61
    v_dot2_f32_bf16 v60, v55, v39, v60
    v_dot2_f32_bf16 v61, v59, v39, v61
    s_nop 1
    v_add_f32_dpp v60, v60, v60 row_shr:1 row_mask:0xf bank_mask:0xf bound_ctrl:0
    v_add_f32_dpp v61, v61, v61 row_shr:1 row_mask:0xf bank_mask:0xf bound_ctrl:0
    s_nop 0
    v_add_f32_dpp v60, v60, v60 row_shr:2 row_mask:0xf bank_mask:0xf bound_ctrl:0
    v_add_f32_dpp v61, v61, v61 row_shr:2 row_mask:0xf bank_mask:0xf bound_ctrl:0
    s_nop 0
    v_add_f32_dpp v60, v60, v60 row_shr:4 row_mask:0xf bank_mask:0xf bound_ctrl:0
    v_add_f32_dpp v61, v61, v61 row_shr:4 row_mask:0xf bank_mask:0xf bound_ctrl:0
    s_nop 0
    v_add_f32_dpp v60, v60, v60 row_shr:8 row_mask:0xf bank_mask:0xf bound_ctrl:0
    v_add_f32_dpp v61, v61, v61 row_shr:8 row_mask:0xf bank_mask:0xf bound_ctrl:0
    s_nop 0
    v_add_f32_dpp v60, v60, v60 row_bcast:15 row_mask:0xa bank_mask:0xf
    v_add_f32_dpp v61, v61, v61 row_bcast:15 row_mask:0xa bank_mask:0xf
    s_nop 0
    v_add_f32_dpp v60, v60, v60 row_bcast:31 row_mask:0xc bank_mask:0xf
    v_add_f32_dpp v61, v61, v61 row_bcast:31 row_mask:0xc bank_mask:0xf
    v_cvt_pk_bf16_f32 v60, v60, v61
    v_and_b32 v61, 0xffff0000, v60
    v_lshlrev_b32 v60, 16, v60
    v_mul_f32 v60, 0xbfb8aa3b, v60
    v_mul_f32 v61, 0xbfb8aa3b, v61
    v_exp_f32 v60, v60
    v_exp_f32 v61, v61
    v_add_f32 v60, 1.0, v60
    v_add_f32 v61, 1.0, v61
    v_rcp_f32 v60, v60
    v_rcp_f32 v61, v61
    s_lshl_b32 s4, s3, 3
    s_add_u32 s4, s4, 33856
    v_mov_b32 v62, s4
    v_cvt_pk_bf16_f32 v60, v60, v61
    v_and_b32 v61, 0xffff0000, v60
    v_lshlrev_b32 v60, 16, v60
    s_mov_b32 exec_lo, 0
    s_mov_b32 exec_hi, 0x80000000
    ds_write_b64 v62, v[60:61]
    s_mov_b64 exec, -1
    v_readlane_b32 s40, v60, 63
    v_readlane_b32 s41, v61, 63
    v_lshrrev_b32 v12, 1, v1
    v_and_b32 v13, 1, v1
    v_lshlrev_b32 v13, 4, v13
    v_lshl_add_u32 v104, v12, 16, v13
    v_lshl_add_u32 v12, v12, 13, v13
    s_lshl_b32 s4, s3, 19
    s_lshl_b32 s5, s60, 10
    s_add_u32 s4, s4, s5
    s_lshl_b32 s5, s61, 5
    s_add_u32 s22, s4, s5
    s_add_u32 s23, s22, 262144
    s_lshl_b32 s63, s60, 5
    s_add_u32 s63, s63, s61
    s_lshl_b32 s63, s63, 13
    s_add_u32 s63, s63, 6291456
    s_add_u32 s62, s63, s24
    v_add_u32 v13, s24, v2
    v_lshl_add_u32 v7, v4, 6, v10
    s_lshl_b32 s4, s3, 3
    v_lshl_add_u32 v110, v7, 5, s4
    v_add_u32 v111, 33920, v110
    s_lshl_b32 s4, s3, 2
    s_add_u32 s4, s4, 25664
    v_lshl_add_u32 v109, v7, 4, s4
    s_mov_b32 s7, 0
    s_lshr_b32 s42, s40, 16
    s_lshr_b32 s43, s41, 16
    s_waitcnt vmcnt(0) lgkmcnt(0)
    s_barrier
    s_cmp_lg_u32 s3, 0
    s_cbranch_scc1 B_S1
    s_mov_b64 exec, 255
    v_mul_u32_u24 v60, 1280, v1
    v_mov_b32 v61, s96
    s_add_u32 s5, s97, 2293760
    buffer_store_dword v61, v60, s[12:15], s5 offen sc0 sc1
    s_mov_b64 exec, -1
B_S1:
    s_lshl_b32 s26, s3, 9
    s_add_u32 s26, s26, s60
    s_mul_i32 s26, s26, 514
    s_lshl_b32 s27, s61, 4
    s_add_u32 s26, s26, s27
    v_mul_u32_u24 v14, 4112, v1
    s_lshl_b32 s27, s3, 10
    s_add_u32 s27, s27, 25664
    s_mov_b32 m0, s27
    s_nop 0
    buffer_load_dwordx4 v14, s[32:35], s26 offen lds
    s_add_u32 m0, s27, 4096
    s_nop 0
    buffer_load_dwordx4 v14, s[36:39], s26 offen lds
    s_getpc_b64 s[20:21]
    s_add_u32 s20, s20, P2_TAB@rel32@lo+4100
    s_addc_u32 s21, s21, P2_TAB@rel32@hi+4108
    global_load_dwordx4 v[112:115], v2, s[20:21] offset:-3072
    global_load_dwordx4 v[116:119], v2, s[20:21] offset:-2048
    global_load_dwordx4 v[120:123], v2, s[20:21] offset:-1024
    global_load_dwordx4 v[124:127], v2, s[20:21] offset:0
    s_cmp_lg_u32 s3, 0
    s_cbranch_scc1 B_S3
    s_and_b32 s5, s2, 7
    s_mul_i32 s5, s5, 1280
    s_mov_b32 s6, 65536
    s_add_u32 s98, s5, 2293760
LPOLL1:
    buffer_load_dwordx4 v[60:63], v2, s[12:15], s98 offen sc1
    s_waitcnt vmcnt(0)
    v_xor_b32 v60, s96, v60
    v_xor_b32 v61, s96, v61
    v_xor_b32 v62, s96, v62
    v_xor_b32 v63, s96, v63
    v_or3_b32 v60, v60, v61, v62
    v_or_b32 v60, v60, v63
    v_cmp_ne_u32 vcc, 0, v60
    s_sub_u32 s6, s6, 1
    s_cbranch_scc1 LPOLX1
    s_cbranch_vccz LPOLX1
    s_sleep 4
    s_branch LPOLL1
LPOLX1:
B_S3:
    s_barrier
    buffer_load_dwordx4 v[16:19], v12, s[12:15], s22 offen sc1
    buffer_load_dwordx4 v[20:23], v12, s[12:15], s23 offen sc1
    s_waitcnt vmcnt(1)
    ds_write_b128 v13, v[16:19] offset:33920
    s_waitcnt vmcnt(0)
    ds_write_b128 v13, v[20:23] offset:34944
    s_waitcnt lgkmcnt(0)
    s_barrier
    ds_read_b64 v[72:73], v111 offset:0
    ds_read_b64 v[76:77], v111 offset:512
    ds_read_b64 v[74:75], v111 offset:1024
    ds_read_b64 v[78:79], v111 offset:1536
    ds_read2st64_b32 v[80:81], v109 offset0:0 offset1:1
    ds_read2st64_b32 v[82:83], v109 offset0:2 offset1:3
    ds_read2st64_b32 v[84:85], v109 offset0:16 offset1:17
    ds_read2st64_b32 v[86:87], v109 offset0:18 offset1:19
    s_waitcnt lgkmcnt(4)
B_FFT:
    v_swap_b32 v73, v76
    v_swap_b32 v75, v78
    s_nop 1
    v_mfma_f32_16x16x32_bf16 v[16:19], v[72:75], v[112:115], 0
    v_mfma_f32_16x16x32_bf16 v[20:23], v[72:75], v[116:119], 0
    v_mfma_f32_16x16x32_bf16 v[24:27], v[76:79], v[112:115], 0
    v_mfma_f32_16x16x32_bf16 v[28:31], v[76:79], v[116:119], 0
    s_waitcnt lgkmcnt(0)
    v_lshlrev_b32 v48, 16, v80
    v_lshlrev_b32 v52, 16, v84
    v_lshlrev_b32 v49, 16, v81
    v_lshlrev_b32 v53, 16, v85
    v_lshlrev_b32 v50, 16, v82
    v_lshlrev_b32 v54, 16, v86
    v_lshlrev_b32 v51, 16, v83
    v_lshlrev_b32 v55, 16, v87
    v_mul_f32 v32, v16, v120
    v_mul_f32 v36, v20, v120
    v_mul_f32 v33, v17, v121
    v_mul_f32 v37, v21, v121
    v_mul_f32 v34, v18, v122
    v_mul_f32 v38, v22, v122
    v_mul_f32 v35, v19, v123
    v_mul_f32 v39, v23, v123
    v_fmac_f32 v32, v20, v124
    v_fma_f32 v36, -v16, v124, v36
    v_fmac_f32 v33, v21, v125
    v_fma_f32 v37, -v17, v125, v37
    v_fmac_f32 v34, v22, v126
    v_fma_f32 v38, -v18, v126, v38
    v_fmac_f32 v35, v23, v127
    v_fma_f32 v39, -v19, v127, v39
    v_cvt_pk_bf16_f32 v72, v32, v36
    v_cvt_pk_bf16_f32 v73, v33, v37
    v_cvt_pk_bf16_f32 v74, v34, v38
    v_cvt_pk_bf16_f32 v75, v35, v39
    s_nop 1
    v_mfma_f32_16x16x32_bf16 v[16:19], v[112:115], v[72:75], 0
    v_mfma_f32_16x16x32_bf16 v[20:23], v[116:119], v[72:75], 0
    v_mul_f32 v40, v24, v120
    v_mul_f32 v44, v28, v120
    v_mul_f32 v41, v25, v121
    v_mul_f32 v45, v29, v121
    v_mul_f32 v42, v26, v122
    v_mul_f32 v46, v30, v122
    v_mul_f32 v43, v27, v123
    v_mul_f32 v47, v31, v123
    v_fmac_f32 v40, v28, v124
    v_fma_f32 v44, -v24, v124, v44
    v_fmac_f32 v41, v29, v125
    v_fma_f32 v45, -v25, v125, v45
    v_fmac_f32 v42, v30, v126
    v_fma_f32 v46, -v26, v126, v46
    v_fmac_f32 v43, v31, v127
    v_fma_f32 v47, -v27, v127, v47
    v_cvt_pk_bf16_f32 v76, v40, v44
    v_cvt_pk_bf16_f32 v77, v41, v45
    v_cvt_pk_bf16_f32 v78, v42, v46
    v_cvt_pk_bf16_f32 v79, v43, v47
    s_nop 1
    v_mfma_f32_16x16x32_bf16 v[24:27], v[112:115], v[76:79], 0
    v_mfma_f32_16x16x32_bf16 v[28:31], v[116:119], v[76:79], 0
    v_and_b32 v56, 0xffff0000, v80
    v_and_b32 v60, 0xffff0000, v84
    v_and_b32 v57, 0xffff0000, v81
    v_and_b32 v61, 0xffff0000, v85
    v_and_b32 v58, 0xffff0000, v82
    v_and_b32 v62, 0xffff0000, v86
    v_and_b32 v59, 0xffff0000, v83
    v_and_b32 v63, 0xffff0000, v87
    v_mul_f32 v32, v16, v48
    v_mul_f32 v36, v20, v48
    v_mul_f32 v33, v17, v49
    v_mul_f32 v37, v21, v49
    v_mul_f32 v34, v18, v50
    v_mul_f32 v38, v22, v50
    v_mul_f32 v35, v19, v51
    v_mul_f32 v39, v23, v51
    v_fma_f32 v32, -v20, v52, v32
    v_fmac_f32 v36, v16, v52
    v_fma_f32 v33, -v21, v53, v33
    v_fmac_f32 v37, v17, v53
    v_fma_f32 v34, -v22, v54, v34
    v_fmac_f32 v38, v18, v54
    v_fma_f32 v35, -v23, v55, v35
    v_fmac_f32 v39, v19, v55
    v_cvt_pk_bf16_f32 v72, v36, v32
    v_cvt_pk_bf16_f32 v73, v37, v33
    v_cvt_pk_bf16_f32 v74, v38, v34
    v_cvt_pk_bf16_f32 v75, v39, v35
    s_nop 1
    v_mfma_f32_16x16x32_bf16 v[16:19], v[72:75], v[112:115], 0
    v_mfma_f32_16x16x32_bf16 v[20:23], v[72:75], v[116:119], 0
    v_mul_f32 v40, v24, v56
    v_mul_f32 v44, v28, v56
    v_mul_f32 v41, v25, v57
    v_mul_f32 v45, v29, v57
    v_mul_f32 v42, v26, v58
    v_mul_f32 v46, v30, v58
    v_mul_f32 v43, v27, v59
    v_mul_f32 v47, v31, v59
    v_fma_f32 v40, -v28, v60, v40
    v_fmac_f32 v44, v24, v60
    v_fma_f32 v41, -v29, v61, v41
    v_fmac_f32 v45, v25, v61
    v_fma_f32 v42, -v30, v62, v42
    v_fmac_f32 v46, v26, v62
    v_fma_f32 v43, -v31, v63, v43
    v_fmac_f32 v47, v27, v63
    v_cvt_pk_bf16_f32 v76, v44, v40
    v_cvt_pk_bf16_f32 v77, v45, v41
    v_cvt_pk_bf16_f32 v78, v46, v42
    v_cvt_pk_bf16_f32 v79, v47, v43
    s_nop 1
    v_mfma_f32_16x16x32_bf16 v[24:27], v[76:79], v[112:115], 0
    v_mfma_f32_16x16x32_bf16 v[28:31], v[76:79], v[116:119], 0
    v_mul_f32 v32, v16, v120
    v_mul_f32 v36, v20, v120
    v_mul_f32 v33, v17, v121
    v_mul_f32 v37, v21, v121
    v_mul_f32 v34, v18, v122
    v_mul_f32 v38, v22, v122
    v_mul_f32 v35, v19, v123
    v_mul_f32 v39, v23, v123
    v_fmac_f32 v32, v20, v124
    v_fma_f32 v36, -v16, v124, v36
    v_fmac_f32 v33, v21, v125
    v_fma_f32 v37, -v17, v125, v37
    v_fmac_f32 v34, v22, v126
    v_fma_f32 v38, -v18, v126, v38
    v_fmac_f32 v35, v23, v127
    v_fma_f32 v39, -v19, v127, v39
    v_cvt_pk_bf16_f32 v72, v32, v36
    v_cvt_pk_bf16_f32 v73, v33, v37
    v_cvt_pk_bf16_f32 v74, v34, v38
    v_cvt_pk_bf16_f32 v75, v35, v39
    s_nop 1
    v_mfma_f32_16x16x32_bf16 v[16:19], v[112:115], v[72:75], 0
    v_mfma_f32_16x16x32_bf16 v[20:23], v[116:119], v[72:75], 0
    v_mul_f32 v40, v24, v120
    v_mul_f32 v44, v28, v120
    v_mul_f32 v41, v25, v121
    v_mul_f32 v45, v29, v121
    v_mul_f32 v42, v26, v122
    v_mul_f32 v46, v30, v122
    v_mul_f32 v43, v27, v123
    v_mul_f32 v47, v31, v123
    v_fmac_f32 v40, v28, v124
    v_fma_f32 v44, -v24, v124, v44
    v_fmac_f32 v41, v29, v125
    v_fma_f32 v45, -v25, v125, v45
    v_fmac_f32 v42, v30, v126
    v_fma_f32 v46, -v26, v126, v46
    v_fmac_f32 v43, v31, v127
    v_fma_f32 v47, -v27, v127, v47
    v_cvt_pk_bf16_f32 v76, v40, v44
    v_cvt_pk_bf16_f32 v77, v41, v45
    v_cvt_pk_bf16_f32 v78, v42, v46
    v_cvt_pk_bf16_f32 v79, v43, v47
    s_nop 1
    v_mfma_f32_16x16x32_bf16 v[24:27], v[112:115], v[76:79], 0
    v_mfma_f32_16x16x32_bf16 v[28:31], v[116:119], v[76:79], 0
    v_cvt_pk_bf16_f32 v48, v20, v16
    v_cvt_pk_bf16_f32 v50, v21, v17
    v_cvt_pk_bf16_f32 v52, v22, v18
    v_cvt_pk_bf16_f32 v54, v23, v19
    s_nop 3
    v_cvt_pk_bf16_f32 v49, v28, v24
    v_cvt_pk_bf16_f32 v51, v29, v25
    v_cvt_pk_bf16_f32 v53, v30, v26
    v_cvt_pk_bf16_f32 v55, v31, v27
    s_cmp_lg_u32 s7, 0
    s_cbranch_scc1 A_NYS
    ds_write_b64 v111, v[48:49] offset:0
    ds_write_b64 v111, v[50:51] offset:512
    ds_write_b64 v111, v[52:53] offset:1024
    ds_write_b64 v111, v[54:55] offset:1536
    s_waitcnt lgkmcnt(0)
    s_barrier
    ds_read_b128 v[64:67], v13 offset:33920
    ds_read_b128 v[68:71], v13 offset:34944
    s_waitcnt lgkmcnt(1)
    buffer_store_dwordx4 v[64:67], v2, s[12:15], s62 offen sc1
    s_waitcnt lgkmcnt(0)
    buffer_store_dwordx4 v[68:71], v2, s[12:15], s62 offen offset:1024 sc1
    s_getpc_b64 s[20:21]
    s_add_u32 s20, s20, P3_TAB@rel32@lo+4100
    s_addc_u32 s21, s21, P3_TAB@rel32@hi+4108
    global_load_dwordx4 v[16:19], v2, s[20:21] offset:-4096
    global_load_dwordx4 v[20:23], v2, s[20:21] offset:-3072
    global_load_dwordx4 v[24:27], v2, s[20:21] offset:-2048
    global_load_dwordx4 v[28:31], v2, s[20:21] offset:-1024
    global_load_dwordx4 v[32:35], v2, s[20:21] offset:0
    global_load_dwordx4 v[36:39], v2, s[20:21] offset:1024
    global_load_dwordx4 v[40:43], v2, s[20:21] offset:2048
    global_load_dwordx4 v[44:47], v2, s[20:21] offset:3072
    v_bfe_u32 v3, v1, 1, 3
    v_lshlrev_b32 v15, 2, v3
    ds_read_b32 v14, v15 offset:33856
    s_mov_b32 s10, 2097152
    s_mov_b32 s11, 0x20000
    v_lshl_add_u32 v5, v3, 8, s52
    v_mul_u32_u24 v6, v4, v5
    v_and_b32 v7, 1, v1
    v_lshlrev_b32 v7, 8, v7
    v_sub_u32 v6, v7, v6
    v_lshlrev_b32 v6, 1, v6
    v_sub_u32 v5, v6, v5
    v_cvt_f32_i32 v6, v6
    v_cvt_f32_i32 v5, v5
    v_mul_f32 v6, 0x3a000000, v6
    v_mul_f32 v5, 0x3a000000, v5
    v_cos_f32 v7, v6
    v_sin_f32 v6, v6
    v_cos_f32 v8, v5
    v_sin_f32 v5, v5
    s_mul_i32 s26, s3, 2624
    s_add_u32 s26, s26, 42112
    v_cmp_eq_u32 vcc, 0, v10
    v_lshl_add_u32 v9, v103, 2, s26
    v_add_u32 v50, 1280, v9
    v_cndmask_b32 v92, 0, -1, vcc
    v_add_u32 v105, s26, v2
    v_lshlrev_b32 v106, 3, v4
    s_lshl_b32 s39, s3, 4
    v_mul_u32_u24 v15, 2624, v4
    v_lshl_add_u32 v15, v10, 2, v15
    v_add_u32 v15, 42112, v15
    s_lshl_b32 s31, s3, 6
    v_add_u32 v11, s31, v15
    v_lshl_add_u32 v107, v4, 5, v10
    v_lshlrev_b32 v107, 5, v107
    s_lshl_b32 s31, s3, 3
    s_add_u32 s31, s31, 52608
    v_add_u32 v107, s31, v107
    v_lshlrev_b32 v108, 5, v10
    v_lshl_add_u32 v108, v4, 3, v108
    s_lshl_b32 s34, s52, 10
    s_lshl_b32 s35, s3, 19
    s_add_u32 s34, s34, s35
    s_add_u32 s35, s34, 0x40000
    s_lshl_b32 s24, s3, 19
    s_add_u32 s24, s24, s53
    s_add_u32 s24, s24, 6291456
    s_add_u32 s25, s24, 262144
    s_add_u32 s38, s53, 2195456
    s_and_b32 s27, s3, 1
    s_lshl_b32 s27, s27, 2
    s_lshr_b32 s28, s3, 1
    s_add_u32 s27, s27, s28
    s_lshl_b32 s27, s27, 13
    s_add_u32 s27, s27, s53
    s_add_u32 s27, s27, 9437184
    s_add_u32 s28, s27, 16384
    s_waitcnt lgkmcnt(0)
    v_sub_f32 v14, 1.0, v14
    v_cvt_pk_bf16_f32 v14, v14, v14
    v_and_b32 v14, 0xffff0000, v14
    v_mul_f32 v7, v14, v7
    v_mul_f32 v6, v14, v6
    v_mul_f32 v8, v14, v8
    v_mul_f32 v5, v14, v5
    v_cvt_pk_bf16_f32 v48, v7, v6
    v_cvt_pk_bf16_f32 v49, v8, v5
    s_cmp_lg_u32 s3, 0
    s_cbranch_scc1 B_S4
    s_and_b32 s5, s2, 7
    s_mul_i32 s5, s5, 1280
    s_mov_b32 s6, 65536
    s_add_u32 s98, s5, 2310144
LPOLL2:
    buffer_load_dwordx4 v[60:63], v2, s[12:15], s98 offen sc1
    s_waitcnt vmcnt(0)
    v_xor_b32 v60, s96, v60
    v_xor_b32 v61, s96, v61
    v_xor_b32 v62, s96, v62
    v_xor_b32 v63, s96, v63
    v_or3_b32 v60, v60, v61, v62
    v_or_b32 v60, v60, v63
    v_cmp_ne_u32 vcc, 0, v60
    s_sub_u32 s6, s6, 1
    s_cbranch_scc1 LPOLX2
    s_cbranch_vccz LPOLX2
    s_sleep 4
    s_branch LPOLL2
LPOLX2:
B_S4:
    s_waitcnt vmcnt(0)
    s_barrier
    s_mov_b32 s6, 65536
LG3:
    buffer_load_dwordx4 v[64:67], v12, s[12:15], s24 offen sc1
    buffer_load_dwordx4 v[68:71], v12, s[12:15], s25 offen sc1
LGC3:
    s_waitcnt vmcnt(0)
    v_max_u32 v60, v64, v68
    v_cmp_eq_u32 vcc, -1, v60
    s_sub_u32 s6, s6, 1
    s_cbranch_scc1 LGX3
    s_and_b64 exec, exec, vcc
    s_cbranch_scc0 LGX3
    s_sleep 1
    s_branch LG3
LGX3:
    s_mov_b64 exec, -1
    ds_write_b128 v105, v[64:67]
    ds_write_b128 v105, v[68:71] offset:1280
    s_waitcnt lgkmcnt(0)
    s_barrier
    ds_read2st64_b32 v[52:53], v11 offset0:0 offset1:5
    ds_read2st64_b32 v[54:55], v11 offset0:1 offset1:6
    ds_read2st64_b32 v[56:57], v11 offset0:2 offset1:7
    ds_read2st64_b32 v[58:59], v11 offset0:3 offset1:8
    s_waitcnt lgkmcnt(3)
    v_mfma_f32_16x16x16_bf16 v[60:63], v[48:49], v[52:53], 0
    s_waitcnt lgkmcnt(2)
    v_mfma_f32_16x16x16_bf16 v[64:67], v[48:49], v[54:55], 0
    s_waitcnt lgkmcnt(1)
    v_mfma_f32_16x16x16_bf16 v[68:71], v[48:49], v[56:57], 0
    s_waitcnt lgkmcnt(0)
    v_mfma_f32_16x16x16_bf16 v[72:75], v[48:49], v[58:59], 0
    s_nop 1
    v_cvt_pk_bf16_f32 v52, v60, v61
    v_cvt_pk_bf16_f32 v53, v62, v63
    ds_write2st64_b32 v11, v52, v53 offset0:0 offset1:5
    v_cvt_pk_bf16_f32 v54, v64, v65
    v_cvt_pk_bf16_f32 v55, v66, v67
    ds_write2st64_b32 v11, v54, v55 offset0:1 offset1:6
    v_cvt_pk_bf16_f32 v56, v68, v69
    v_cvt_pk_bf16_f32 v57, v70, v71
    ds_write2st64_b32 v11, v56, v57 offset0:2 offset1:7
    v_cvt_pk_bf16_f32 v58, v72, v73
    v_cvt_pk_bf16_f32 v59, v74, v75
    ds_write2st64_b32 v11, v58, v59 offset0:3 offset1:8
    s_waitcnt lgkmcnt(0)
    s_barrier
    ds_read2_b32 v[52:53], v9 offset1:32
    ds_read2_b32 v[54:55], v9 offset0:64 offset1:96
    ds_read2_b32 v[60:61], v50 offset1:32
    ds_read2_b32 v[62:63], v50 offset0:64 offset1:96
    s_waitcnt lgkmcnt(2)
    v_and_b32 v56, v92, v52
    v_and_b32 v57, v92, v53
    v_and_b32 v58, v92, v54
    v_and_b32 v59, v92, v55
    v_mfma_f32_16x16x32_bf16 v[68:71], v[52:55], v[16:19], 0
    v_mfma_f32_16x16x32_bf16 v[72:75], v[52:55], v[20:23], 0
    v_mfma_f32_16x16x32_bf16 v[68:71], v[56:59], v[24:27], v[68:71]
    v_mfma_f32_16x16x32_bf16 v[72:75], v[56:59], v[28:31], v[72:75]
    s_waitcnt lgkmcnt(0)
    v_and_b32 v64, v92, v60
    v_and_b32 v65, v92, v61
    v_and_b32 v66, v92, v62
    v_and_b32 v67, v92, v63
    v_mfma_f32_16x16x32_bf16 v[76:79], v[60:63], v[16:19], 0
    v_mfma_f32_16x16x32_bf16 v[80:83], v[60:63], v[20:23], 0
    v_mfma_f32_16x16x32_bf16 v[76:79], v[64:67], v[24:27], v[76:79]
    v_mfma_f32_16x16x32_bf16 v[80:83], v[64:67], v[28:31], v[80:83]
    v_mul_f32 v84, v68, v32
    v_mul_f32 v88, v72, v32
    v_mul_f32 v85, v69, v33
    v_mul_f32 v89, v73, v33
    v_mul_f32 v86, v70, v34
    v_mul_f32 v90, v74, v34
    v_mul_f32 v87, v71, v35
    v_mul_f32 v91, v75, v35
    v_fma_f32 v84, -v72, v36, v84
    v_fmac_f32 v88, v68, v36
    v_fma_f32 v85, -v73, v37, v85
    v_fmac_f32 v89, v69, v37
    v_fma_f32 v86, -v74, v38, v86
    v_fmac_f32 v90, v70, v38
    v_fma_f32 v87, -v75, v39, v87
    v_fmac_f32 v91, v71, v39
    v_cvt_pk_bf16_f32 v52, v84, v88
    v_cvt_pk_bf16_f32 v53, v85, v89
    v_cvt_pk_bf16_f32 v54, v86, v90
    v_cvt_pk_bf16_f32 v55, v87, v91
    s_nop 1
    v_mfma_f32_16x16x32_bf16 v[68:71], v[52:55], v[40:43], 0
    v_mfma_f32_16x16x32_bf16 v[72:75], v[52:55], v[44:47], 0
    v_mul_f32 v84, v76, v32
    v_mul_f32 v88, v80, v32
    v_mul_f32 v85, v77, v33
    v_mul_f32 v89, v81, v33
    v_mul_f32 v86, v78, v34
    v_mul_f32 v90, v82, v34
    v_mul_f32 v87, v79, v35
    v_mul_f32 v91, v83, v35
    v_fma_f32 v84, -v80, v36, v84
    v_fmac_f32 v88, v76, v36
    v_fma_f32 v85, -v81, v37, v85
    v_fmac_f32 v89, v77, v37
    v_fma_f32 v86, -v82, v38, v86
    v_fmac_f32 v90, v78, v38
    v_fma_f32 v87, -v83, v39, v87
    v_fmac_f32 v91, v79, v39
    v_cvt_pk_bf16_f32 v56, v84, v88
    v_cvt_pk_bf16_f32 v57, v85, v89
    v_cvt_pk_bf16_f32 v58, v86, v90
    v_cvt_pk_bf16_f32 v59, v87, v91
    s_nop 1
    v_mfma_f32_16x16x32_bf16 v[76:79], v[56:59], v[40:43], 0
    v_mfma_f32_16x16x32_bf16 v[80:83], v[56:59], v[44:47], 0
    s_cmp_lg_u32 s3, 0
    s_cbranch_scc1 B_S5
    s_and_b32 s5, s2, 7
    s_mul_i32 s5, s5, 1280
    s_mov_b32 s6, 65536
    s_add_u32 s98, s5, 2326528
LPOLL4:
    buffer_load_dwordx4 v[60:63], v2, s[12:15], s98 offen sc1
    s_waitcnt vmcnt(0)
    v_xor_b32 v60, s96, v60
    v_xor_b32 v61, s96, v61
    v_xor_b32 v62, s96, v62
    v_xor_b32 v63, s96, v63
    v_or3_b32 v60, v60, v61, v62
    v_or_b32 v60, v60, v63
    v_cmp_ne_u32 vcc, 0, v60
    s_sub_u32 s6, s6, 1
    s_cbranch_scc1 LPOLX4
    s_cbranch_vccz LPOLX4
    s_sleep 4
    s_branch LPOLL4
LPOLX4:
B_S5:
    s_barrier
    s_mov_b32 s6, 65536
LG5:
    buffer_load_dwordx2 v[24:25], v106, s[12:15], s38 offen sc1
LGC5:
    s_waitcnt vmcnt(0)
    v_max_u32 v60, v24, v24
    v_cmp_eq_u32 vcc, -1, v60
    s_sub_u32 s6, s6, 1
    s_cbranch_scc1 LGX5
    s_and_b64 exec, exec, vcc
    s_cbranch_scc0 LGX5
    s_sleep 1
    s_branch LG5
LGX5:
    s_mov_b64 exec, -1
    v_mfma_f32_16x16x16_bf16 v[28:31], v[48:49], v[24:25], 0
    s_nop 7
    v_mul_f32 v28, 0x35800000, v28
    v_mul_f32 v30, 0x35800000, v30
    v_readlane_b32 s44, v28, s39
    v_readlane_b32 s45, v30, s39
    s_nop 0
    v_add_f32 v68, s44, v68
    v_subrev_f32 v69, s44, v69
    v_add_f32 v70, s44, v70
    v_subrev_f32 v71, s44, v71
    v_add_f32 v72, s44, v72
    v_subrev_f32 v73, s44, v73
    v_add_f32 v74, s44, v74
    v_subrev_f32 v75, s44, v75
    v_add_f32 v76, s45, v76
    v_subrev_f32 v77, s45, v77
    v_add_f32 v78, s45, v78
    v_subrev_f32 v79, s45, v79
    v_add_f32 v80, s45, v80
    v_subrev_f32 v81, s45, v81
    v_add_f32 v82, s45, v82
    v_subrev_f32 v83, s45, v83
    s_mov_b32 s6, 65536
LG6:
    buffer_load_dwordx4 v[16:19], v104, s[12:15], s27 offen sc1
    buffer_load_dwordx4 v[20:23], v104, s[12:15], s28 offen sc1
LGC6:
    s_waitcnt vmcnt(0)
    v_max_u32 v60, v16, v20
    v_cmp_eq_u32 vcc, -1, v60
    s_sub_u32 s6, s6, 1
    s_cbranch_scc1 LGX6
    s_and_b64 exec, exec, vcc
    s_cbranch_scc0 LGX6
    s_sleep 1
    s_branch LG6
LGX6:
    s_mov_b64 exec, -1
    ds_write_b128 v13, v[16:19] offset:52608
    ds_write_b128 v13, v[20:23] offset:53632
    s_waitcnt lgkmcnt(0)
    s_barrier
    ds_read_b64 v[96:97], v107 offset:0
    ds_read_b64 v[98:99], v107 offset:4096
    ds_read_b64 v[100:101], v107 offset:512
    ds_read_b64 v[102:103], v107 offset:4608
    s_waitcnt lgkmcnt(2)
    s_nop 0
    v_dot2_f32_bf16 v68, v96, s42, v68
    v_dot2_f32_bf16 v69, v96, s40, v69
    v_dot2_f32_bf16 v70, v98, s42, v70
    v_dot2_f32_bf16 v71, v98, s40, v71
    v_dot2_f32_bf16 v76, v97, s43, v76
    v_dot2_f32_bf16 v77, v97, s41, v77
    v_dot2_f32_bf16 v78, v99, s43, v78
    v_dot2_f32_bf16 v79, v99, s41, v79
    v_cvt_pk_bf16_f32 v60, v68, v69
    v_cvt_pk_bf16_f32 v61, v70, v71
    buffer_store_dwordx2 v[60:61], v108, s[8:11], s34 offen offset:0
    v_cvt_pk_bf16_f32 v64, v76, v77
    v_cvt_pk_bf16_f32 v65, v78, v79
    buffer_store_dwordx2 v[64:65], v108, s[8:11], s35 offen offset:0
    s_waitcnt lgkmcnt(0)
    s_nop 0
    v_dot2_f32_bf16 v72, v100, s42, v72
    v_dot2_f32_bf16 v73, v100, s40, v73
    v_dot2_f32_bf16 v74, v102, s42, v74
    v_dot2_f32_bf16 v75, v102, s40, v75
    v_dot2_f32_bf16 v80, v101, s43, v80
    v_dot2_f32_bf16 v81, v101, s41, v81
    v_dot2_f32_bf16 v82, v103, s43, v82
    v_dot2_f32_bf16 v83, v103, s41, v83
    v_cvt_pk_bf16_f32 v62, v72, v73
    v_cvt_pk_bf16_f32 v63, v74, v75
    buffer_store_dwordx2 v[62:63], v108, s[8:11], s34 offen offset:512
    v_cvt_pk_bf16_f32 v66, v80, v81
    v_cvt_pk_bf16_f32 v67, v82, v83
    buffer_store_dwordx2 v[66:67], v108, s[8:11], s35 offen offset:512
    s_or_b32 s4, s2, s3
    s_cmp_lg_u32 s4, 0
    s_cbranch_scc1 L_END
    s_mov_b64 exec, 1
    v_mov_b32 v60, 0
    v_mov_b32 v61, s96
    s_mov_b32 s4, 2359296
    buffer_store_dword v61, v60, s[12:15], s4 offen sc1
L_END:
    s_endpgm
A_IN:
    s_cmpk_ge_u32 s2, 512
    s_cbranch_scc1 L_EXIT
    s_sub_u32 s58, s2, 256
    s_and_b32 s27, s3, 1
    s_bfe_u32 s26, s3, 0x10001
    s_lshl_b32 s28, s58, 9
    s_lshl_b32 s29, s26, 8
    s_add_u32 s28, s28, s29
    s_lshl_b32 s29, s27, 7
    s_add_u32 s28, s28, s29
    v_lshl_add_u32 v5, v1, 1, s28
    s_lshl_b32 s29, s58, 2
    s_lshl_b32 s52, s26, 4
    s_sub_u32 s52, 16, s52
    v_mov_b32 v13, 0x3fb8aa3b
    s_getpc_b64 s[20:21]
    s_add_u32 s20, s20, P2_TAB@rel32@lo+4100
    s_addc_u32 s21, s21, P2_TAB@rel32@hi+4108
    s_mov_b32 s4, 2359296
    s_lshl_b32 s54, s27, 8
    s_cmp_ge_u32 s3, 4
    s_waitcnt lgkmcnt(0)
    s_load_dword s30, s[44:45], s29
    s_load_dword s31, s[46:47], s29
    s_load_dword s96, s[12:13], s4
    global_load_ushort v11, v5, s[32:33]
    global_load_ushort v12, v5, s[34:35]
    s_cbranch_scc0 A_P
    global_load_ushort v18, v5, s[36:37]
    global_load_ushort v19, v5, s[38:39]
    global_load_ushort v20, v5, s[40:41]
    global_load_ushort v21, v5, s[42:43]
A_P:
    v_and_b32 v3, 0xff, v0
    v_lshlrev_b32 v6, 5, v3
    s_lshr_b32 s24, s3, 2
    s_mul_i32 s25, s24, 4672
    s_add_u32 s25, s25, 57664
    v_lshl_add_u32 v126, v3, 4, s25
    s_mul_i32 s23, s24, 16640
    s_add_u32 s23, s23, 64
    v_lshl_add_u32 v127, v3, 4, s23
    s_and_b32 s23, s3, 3
    s_cmp_ge_u32 s23, 1
    s_cselect_b64 s[56:57], -1, 0
    s_cmp_ge_u32 s23, 2
    s_cselect_b64 s[62:63], -1, 0
    v_mov_b32 v104, 0
    v_mov_b32 v105, 0
    v_mov_b32 v7, s25
    ds_write_b64 v7, v[104:105] offset:8
    s_mul_i32 s22, s27, 1280
    s_mul_i32 s23, s26, 2592
    s_mul_i32 s25, s24, 5200
    s_add_u32 s22, s22, s23
    s_add_u32 s22, s22, s25
    s_add_u32 s22, s22, 67072
    v_lshl_add_u32 v7, v1, 2, s22
    ds_write_b32 v7, v104
    s_mul_i32 s23, s3, 4160
    v_lshl_add_u32 v113, v10, 2, s23
    s_waitcnt lgkmcnt(0)
    s_lshl_b32 s30, s30, s52
    s_and_b32 s30, s30, 0xffff0000
    v_mul_f32 v14, s30, v13
    v_exp_f32 v14, v14
    s_add_u32 s96, s96, 1
    v_cvt_pk_bf16_f32 v14, v14, v14
    v_and_b32 v14, 0xffff0000, v14
    v_mul_f32 v13, v14, v13
    v_mul_f32 v15, 0.15915494, v14
    s_cmp_ge_u32 s3, 4
    s_cbranch_scc1 A_B
    v_lshrrev_b32 v22, 3, v1
    v_and_b32 v7, 7, v1
    v_lshlrev_b32 v8, 15, v22
    v_lshl_add_u32 v8, v7, 4, v8
    s_lshl_b32 s28, s58, 7
    s_lshl_b32 s29, s3, 19
    s_add_u32 s28, s28, s29
    s_add_u32 s28, s28, 3145728
    s_add_u32 s29, s28, 0x40000
    v_and_b32 v9, 1, v7
    v_mul_u32_u24 v9, 2592, v9
    v_bfe_u32 v19, v7, 1, 1
    v_mul_u32_u24 v19, 1280, v19
    v_lshrrev_b32 v7, 2, v7
    v_mul_u32_u24 v7, 5200, v7
    v_add3_u32 v9, v9, v19, v7
    s_lshl_b32 s22, s3, 8
    s_add_u32 s22, s22, 67328
    v_lshl_add_u32 v22, v22, 4, s22
    v_add_u32 v119, v22, v9
    s_mul_i32 s22, s26, 16640
    s_lshl_b32 s59, s27, 5
    s_add_u32 s22, s22, s59
    s_add_u32 s22, s22, 56
    v_bfe_u32 v18, v1, 2, 2
    v_mul_u32_u24 v18, 4160, v18
    v_and_b32 v17, 3, v1
    v_lshl_add_u32 v18, v17, 3, v18
    v_and_b32 v17, 16, v1
    v_lshlrev_b32 v17, 1, v17
    v_sub_u32 v18, v18, v17
    v_and_b32 v17, 32, v1
    v_lshrrev_b32 v17, 1, v17
    v_sub_u32 v18, v18, v17
    v_add_u32 v112, s22, v18
    s_mul_i32 s22, s26, 5200
    s_add_u32 s22, s22, 67072
    v_and_b32 v18, 1, v4
    v_mul_u32_u24 v18, 1280, v18
    v_lshrrev_b32 v17, 5, v1
    v_mul_u32_u24 v17, 2592, v17
    v_lshl_add_u32 v18, v10, 4, v18
    v_add3_u32 v117, v18, v17, s22
    s_mul_i32 s22, s26, 4672
    s_add_u32 s22, s22, s59
    s_add_u32 s22, s22, 57664
    v_mul_u32_u24 v18, 72, v10
    v_lshl_add_u32 v18, v4, 3, v18
    v_add_u32 v116, s22, v18
    v_and_b32 v20, 62, v0
    v_and_b32 v21, 1, v0
    s_mul_i32 s22, s3, 72
    s_add_u32 s22, s22, 57664
    v_mul_u32_u24 v21, 2368, v21
    v_add3_u32 v118, v21, v20, s22
    s_mov_b32 s59, 0x05040100
    s_mul_i32 s53, s26, 17408
    s_add_u32 m0, s53, s54
    v_lshl_add_u32 v16, s27, 4, v10
    v_mul_u32_u24 v16, 544, v16
    v_lshl_add_u32 v16, v4, 4, v16
    v_add_u32 v46, s53, v16
    s_mul_i32 s53, s26, 11424
    s_add_u32 s53, s53, 34816
    v_mul_u32_u24 v16, 544, v10
    v_lshl_add_u32 v16, v4, 4, v16
    v_add_u32 v47, s53, v16
    s_lshl_b32 s31, s31, s52
    s_and_b32 s31, s31, 0xffff0000
    s_cmp_eq_u32 s27, 0
    s_cselect_b32 s31, s31, 0
    v_cmp_eq_u32 vcc, 0, v1
    v_mov_b32 v16, s31
    v_mov_b32 v20, 1.0
    v_mov_b32 v21, 0
    v_cndmask_b32 v45, 0, v16, vcc
    s_waitcnt vmcnt(0)
    global_load_dwordx4 v[120:123], v6, s[20:21] offset:1024
    global_load_dwordx2 v[124:125], v6, s[20:21] offset:1040
    global_load_dwordx2 v[114:115], v2, s[20:21] offset:-4096
    v_lshlrev_b32 v11, 16, v11
    v_lshlrev_b32 v12, 16, v12
    v_mul_f32 v11, v13, v11
    v_mul_f32 v12, v15, v12
    v_mul_f32 v30, 0x41000000, v11
    v_mul_f32 v31, 0x41000000, v12
    v_mul_f32 v32, 0x42000000, v11
    v_mul_f32 v33, 0x42000000, v12
    v_exp_f32 v30, v30
    v_fract_f32 v31, v31
    v_exp_f32 v32, v32
    v_fract_f32 v33, v33
    v_cos_f32 v22, v31
    v_sin_f32 v23, v31
    v_cos_f32 v28, v33
    v_sin_f32 v29, v33
    v_pk_mul_f32 v[22:23], v[22:23], v[30:31] op_sel_hi:[1,0]
    v_pk_mul_f32 v[28:29], v[28:29], v[32:33] op_sel_hi:[1,0]
    v_pk_mul_f32 v[30:31], v[22:23], v[22:23] op_sel_hi:[0,1]
    v_pk_fma_f32 v[24:25], v[22:23], v[22:23], v[30:31] op_sel:[1,1,0] op_sel_hi:[1,0,1] neg_lo:[0,1,0]
    v_pk_mul_f32 v[30:31], v[24:25], v[22:23] op_sel_hi:[0,1]
    v_pk_fma_f32 v[26:27], v[24:25], v[22:23], v[30:31] op_sel:[1,1,0] op_sel_hi:[1,0,1] neg_lo:[0,1,0]
    v_cvt_pk_bf16_f32 v16, v20, v21
    v_cvt_pk_bf16_f32 v17, v22, v23
    v_cvt_pk_bf16_f32 v18, v24, v25
    v_cvt_pk_bf16_f32 v19, v26, v27
    v_pk_mul_f32 v[30:31], v[20:21], v[28:29] op_sel_hi:[0,1]
    ds_write_addtid_b32 v16 offset:0
    v_pk_mul_f32 v[32:33], v[22:23], v[28:29] op_sel_hi:[0,1]
    ds_write_addtid_b32 v17 offset:544
    v_pk_mul_f32 v[34:35], v[24:25], v[28:29] op_sel_hi:[0,1]
    ds_write_addtid_b32 v18 offset:1088
    v_pk_mul_f32 v[36:37], v[26:27], v[28:29] op_sel_hi:[0,1]
    ds_write_addtid_b32 v19 offset:1632
    v_pk_fma_f32 v[20:21], v[20:21], v[28:29], v[30:31] op_sel:[1,1,0] op_sel_hi:[1,0,1] neg_lo:[0,1,0]
    v_pk_fma_f32 v[22:23], v[22:23], v[28:29], v[32:33] op_sel:[1,1,0] op_sel_hi:[1,0,1] neg_lo:[0,1,0]
    v_pk_fma_f32 v[24:25], v[24:25], v[28:29], v[34:35] op_sel:[1,1,0] op_sel_hi:[1,0,1] neg_lo:[0,1,0]
    v_pk_fma_f32 v[26:27], v[26:27], v[28:29], v[36:37] op_sel:[1,1,0] op_sel_hi:[1,0,1] neg_lo:[0,1,0]
    v_cvt_pk_bf16_f32 v16, v20, v21
    v_cvt_pk_bf16_f32 v17, v22, v23
    v_cvt_pk_bf16_f32 v18, v24, v25
    v_cvt_pk_bf16_f32 v19, v26, v27
    v_pk_mul_f32 v[30:31], v[20:21], v[28:29] op_sel_hi:[0,1]
    ds_write_addtid_b32 v16 offset:2176
    v_pk_mul_f32 v[32:33], v[22:23], v[28:29] op_sel_hi:[0,1]
    ds_write_addtid_b32 v17 offset:2720
    v_pk_mul_f32 v[34:35], v[24:25], v[28:29] op_sel_hi:[0,1]
    ds_write_addtid_b32 v18 offset:3264
    v_pk_mul_f32 v[36:37], v[26:27], v[28:29] op_sel_hi:[0,1]
    ds_write_addtid_b32 v19 offset:3808
    v_pk_fma_f32 v[20:21], v[20:21], v[28:29], v[30:31] op_sel:[1,1,0] op_sel_hi:[1,0,1] neg_lo:[0,1,0]
    v_pk_fma_f32 v[22:23], v[22:23], v[28:29], v[32:33] op_sel:[1,1,0] op_sel_hi:[1,0,1] neg_lo:[0,1,0]
    v_pk_fma_f32 v[24:25], v[24:25], v[28:29], v[34:35] op_sel:[1,1,0] op_sel_hi:[1,0,1] neg_lo:[0,1,0]
    v_pk_fma_f32 v[26:27], v[26:27], v[28:29], v[36:37] op_sel:[1,1,0] op_sel_hi:[1,0,1] neg_lo:[0,1,0]
    v_cvt_pk_bf16_f32 v16, v20, v21
    v_cvt_pk_bf16_f32 v17, v22, v23
    v_cvt_pk_bf16_f32 v18, v24, v25
    v_cvt_pk_bf16_f32 v19, v26, v27
    v_pk_mul_f32 v[30:31], v[20:21], v[28:29] op_sel_hi:[0,1]
    ds_write_addtid_b32 v16 offset:4352
    v_pk_mul_f32 v[32:33], v[22:23], v[28:29] op_sel_hi:[0,1]
    ds_write_addtid_b32 v17 offset:4896
    v_pk_mul_f32 v[34:35], v[24:25], v[28:29] op_sel_hi:[0,1]
    ds_write_addtid_b32 v18 offset:5440
    v_pk_mul_f32 v[36:37], v[26:27], v[28:29] op_sel_hi:[0,1]
    ds_write_addtid_b32 v19 offset:5984
    v_pk_fma_f32 v[20:21], v[20:21], v[28:29], v[30:31] op_sel:[1,1,0] op_sel_hi:[1,0,1] neg_lo:[0,1,0]
    v_pk_fma_f32 v[22:23], v[22:23], v[28:29], v[32:33] op_sel:[1,1,0] op_sel_hi:[1,0,1] neg_lo:[0,1,0]
    v_pk_fma_f32 v[24:25], v[24:25], v[28:29], v[34:35] op_sel:[1,1,0] op_sel_hi:[1,0,1] neg_lo:[0,1,0]
    v_pk_fma_f32 v[26:27], v[26:27], v[28:29], v[36:37] op_sel:[1,1,0] op_sel_hi:[1,0,1] neg_lo:[0,1,0]
    v_cvt_pk_bf16_f32 v16, v20, v21
    v_cvt_pk_bf16_f32 v17, v22, v23
    v_cvt_pk_bf16_f32 v18, v24, v25
    v_cvt_pk_bf16_f32 v19, v26, v27
    v_pk_mul_f32 v[30:31], v[20:21], v[28:29] op_sel_hi:[0,1]
    ds_write_addtid_b32 v16 offset:6528
    v_pk_mul_f32 v[32:33], v[22:23], v[28:29] op_sel_hi:[0,1]
    ds_write_addtid_b32 v17 offset:7072
    v_pk_mul_f32 v[34:35], v[24:25], v[28:29] op_sel_hi:[0,1]
    ds_write_addtid_b32 v18 offset:7616
    v_pk_mul_f32 v[36:37], v[26:27], v[28:29] op_sel_hi:[0,1]
    ds_write_addtid_b32 v19 offset:8160
    v_pk_fma_f32 v[20:21], v[20:21], v[28:29], v[30:31] op_sel:[1,1,0] op_sel_hi:[1,0,1] neg_lo:[0,1,0]
    v_pk_fma_f32 v[22:23], v[22:23], v[28:29], v[32:33] op_sel:[1,1,0] op_sel_hi:[1,0,1] neg_lo:[0,1,0]
    v_pk_fma_f32 v[24:25], v[24:25], v[28:29], v[34:35] op_sel:[1,1,0] op_sel_hi:[1,0,1] neg_lo:[0,1,0]
    v_pk_fma_f32 v[26:27], v[26:27], v[28:29], v[36:37] op_sel:[1,1,0] op_sel_hi:[1,0,1] neg_lo:[0,1,0]
    v_cvt_pk_bf16_f32 v16, v20, v21
    v_cvt_pk_bf16_f32 v17, v22, v23
    v_cvt_pk_bf16_f32 v18, v24, v25
    v_cvt_pk_bf16_f32 v19, v26, v27
    v_pk_mul_f32 v[30:31], v[20:21], v[28:29] op_sel_hi:[0,1]
    ds_write_addtid_b32 v16 offset:8704
    v_pk_mul_f32 v[32:33], v[22:23], v[28:29] op_sel_hi:[0,1]
    ds_write_addtid_b32 v17 offset:9248
    v_pk_mul_f32 v[34:35], v[24:25], v[28:29] op_sel_hi:[0,1]
    ds_write_addtid_b32 v18 offset:9792
    v_pk_mul_f32 v[36:37], v[26:27], v[28:29] op_sel_hi:[0,1]
    ds_write_addtid_b32 v19 offset:10336
    v_pk_fma_f32 v[20:21], v[20:21], v[28:29], v[30:31] op_sel:[1,1,0] op_sel_hi:[1,0,1] neg_lo:[0,1,0]
    v_pk_fma_f32 v[22:23], v[22:23], v[28:29], v[32:33] op_sel:[1,1,0] op_sel_hi:[1,0,1] neg_lo:[0,1,0]
    v_pk_fma_f32 v[24:25], v[24:25], v[28:29], v[34:35] op_sel:[1,1,0] op_sel_hi:[1,0,1] neg_lo:[0,1,0]
    v_pk_fma_f32 v[26:27], v[26:27], v[28:29], v[36:37] op_sel:[1,1,0] op_sel_hi:[1,0,1] neg_lo:[0,1,0]
    v_cvt_pk_bf16_f32 v16, v20, v21
    v_cvt_pk_bf16_f32 v17, v22, v23
    v_cvt_pk_bf16_f32 v18, v24, v25
    v_cvt_pk_bf16_f32 v19, v26, v27
    v_pk_mul_f32 v[30:31], v[20:21], v[28:29] op_sel_hi:[0,1]
    ds_write_addtid_b32 v16 offset:10880
    v_pk_mul_f32 v[32:33], v[22:23], v[28:29] op_sel_hi:[0,1]
    ds_write_addtid_b32 v17 offset:11424
    v_pk_mul_f32 v[34:35], v[24:25], v[28:29] op_sel_hi:[0,1]
    ds_write_addtid_b32 v18 offset:11968
    v_pk_mul_f32 v[36:37], v[26:27], v[28:29] op_sel_hi:[0,1]
    ds_write_addtid_b32 v19 offset:12512
    v_pk_fma_f32 v[20:21], v[20:21], v[28:29], v[30:31] op_sel:[1,1,0] op_sel_hi:[1,0,1] neg_lo:[0,1,0]
    v_pk_fma_f32 v[22:23], v[22:23], v[28:29], v[32:33] op_sel:[1,1,0] op_sel_hi:[1,0,1] neg_lo:[0,1,0]
    v_pk_fma_f32 v[24:25], v[24:25], v[28:29], v[34:35] op_sel:[1,1,0] op_sel_hi:[1,0,1] neg_lo:[0,1,0]
    v_pk_fma_f32 v[26:27], v[26:27], v[28:29], v[36:37] op_sel:[1,1,0] op_sel_hi:[1,0,1] neg_lo:[0,1,0]
    v_cvt_pk_bf16_f32 v16, v20, v21
    v_cvt_pk_bf16_f32 v17, v22, v23
    v_cvt_pk_bf16_f32 v18, v24, v25
    v_cvt_pk_bf16_f32 v19, v26, v27
    v_pk_mul_f32 v[30:31], v[20:21], v[28:29] op_sel_hi:[0,1]
    ds_write_addtid_b32 v16 offset:13056
    v_pk_mul_f32 v[32:33], v[22:23], v[28:29] op_sel_hi:[0,1]
    ds_write_addtid_b32 v17 offset:13600
    v_pk_mul_f32 v[34:35], v[24:25], v[28:29] op_sel_hi:[0,1]
    ds_write_addtid_b32 v18 offset:14144
    v_pk_mul_f32 v[36:37], v[26:27], v[28:29] op_sel_hi:[0,1]
    ds_write_addtid_b32 v19 offset:14688
    v_pk_fma_f32 v[20:21], v[20:21], v[28:29], v[30:31] op_sel:[1,1,0] op_sel_hi:[1,0,1] neg_lo:[0,1,0]
    v_pk_fma_f32 v[22:23], v[22:23], v[28:29], v[32:33] op_sel:[1,1,0] op_sel_hi:[1,0,1] neg_lo:[0,1,0]
    v_pk_fma_f32 v[24:25], v[24:25], v[28:29], v[34:35] op_sel:[1,1,0] op_sel_hi:[1,0,1] neg_lo:[0,1,0]
    v_pk_fma_f32 v[26:27], v[26:27], v[28:29], v[36:37] op_sel:[1,1,0] op_sel_hi:[1,0,1] neg_lo:[0,1,0]
    v_cvt_pk_bf16_f32 v16, v20, v21
    v_cvt_pk_bf16_f32 v17, v22, v23
    v_cvt_pk_bf16_f32 v18, v24, v25
    v_cvt_pk_bf16_f32 v19, v26, v27
    ds_write_addtid_b32 v16 offset:15232
    ds_write_addtid_b32 v17 offset:15776
    ds_write_addtid_b32 v18 offset:16320
    ds_write_addtid_b32 v19 offset:16864
    s_mul_i32 s31, s26, 4672
    s_add_u32 s31, s31, s54
    s_add_u32 s31, s31, 57680
    v_lshl_add_u32 v16, v4, 6, s31
    s_waitcnt vmcnt(0)
    v_add_u32 v114, v114, v16
    v_add_u32 v115, v115, v16
    s_waitcnt lgkmcnt(0)
    s_barrier
    ds_read_b128 v[48:51], v46 offset:0
    ds_read_b128 v[52:55], v47 offset:0
    ds_read_b128 v[56:59], v47 offset:8704
    ds_read_b128 v[60:63], v46 offset:64
    ds_read_b128 v[64:67], v47 offset:64
    ds_read_b128 v[68:71], v47 offset:8768
    ds_read_b128 v[72:75], v46 offset:128
    ds_read_b128 v[76:79], v47 offset:128
    ds_read_b128 v[80:83], v47 offset:8832
    ds_read_b128 v[84:87], v46 offset:192
    ds_read_b128 v[88:91], v47 offset:192
    ds_read_b128 v[92:95], v47 offset:8896
    s_waitcnt lgkmcnt(9)
    v_mfma_f32_16x16x32_bf16 v[16:19], v[48:51], v[52:55], 0
    v_mfma_f32_16x16x32_bf16 v[20:23], v[48:51], v[56:59], 0
    ds_read_b128 v[48:51], v46 offset:256
    ds_read_b128 v[52:55], v47 offset:256
    ds_read_b128 v[56:59], v47 offset:8960
    s_waitcnt lgkmcnt(9)
    v_mfma_f32_16x16x32_bf16 v[16:19], v[60:63], v[64:67], v[16:19]
    v_mfma_f32_16x16x32_bf16 v[20:23], v[60:63], v[68:71], v[20:23]
    ds_read_b128 v[60:63], v46 offset:320
    ds_read_b128 v[64:67], v47 offset:320
    ds_read_b128 v[68:71], v47 offset:9024
    s_waitcnt lgkmcnt(9)
    v_mfma_f32_16x16x32_bf16 v[16:19], v[72:75], v[76:79], v[16:19]
    v_mfma_f32_16x16x32_bf16 v[20:23], v[72:75], v[80:83], v[20:23]
    ds_read_b128 v[72:75], v46 offset:384
    ds_read_b128 v[76:79], v47 offset:384
    ds_read_b128 v[80:83], v47 offset:9088
    s_waitcnt lgkmcnt(9)
    v_mfma_f32_16x16x32_bf16 v[16:19], v[84:87], v[88:91], v[16:19]
    v_mfma_f32_16x16x32_bf16 v[20:23], v[84:87], v[92:95], v[20:23]
    ds_read_b128 v[84:87], v46 offset:448
    ds_read_b128 v[88:91], v47 offset:448
    ds_read_b128 v[92:95], v47 offset:9152
    s_waitcnt lgkmcnt(9)
    v_mfma_f32_16x16x32_bf16 v[16:19], v[48:51], v[52:55], v[16:19]
    v_mfma_f32_16x16x32_bf16 v[20:23], v[48:51], v[56:59], v[20:23]
    s_waitcnt lgkmcnt(6)
    v_mfma_f32_16x16x32_bf16 v[16:19], v[60:63], v[64:67], v[16:19]
    v_mfma_f32_16x16x32_bf16 v[20:23], v[60:63], v[68:71], v[20:23]
    s_waitcnt lgkmcnt(3)
    v_mfma_f32_16x16x32_bf16 v[16:19], v[72:75], v[76:79], v[16:19]
    v_mfma_f32_16x16x32_bf16 v[20:23], v[72:75], v[80:83], v[20:23]
    s_waitcnt lgkmcnt(0)
    v_mfma_f32_16x16x32_bf16 v[16:19], v[84:87], v[88:91], v[16:19]
    v_mfma_f32_16x16x32_bf16 v[20:23], v[84:87], v[92:95], v[20:23]
    s_nop 6
    v_add_f32 v16, v45, v16
    v_cvt_pk_bf16_f32 v24, v16, v17
    v_cvt_pk_bf16_f32 v25, v18, v19
    v_cvt_pk_bf16_f32 v26, v20, v21
    v_cvt_pk_bf16_f32 v27, v22, v23
    ds_write_b16 v114, v24 offset:0
    ds_write_b16_d16_hi v114, v24 offset:16
    ds_write_b16 v114, v25 offset:32
    ds_write_b16_d16_hi v114, v25 offset:48
    ds_write_b16 v115, v26 offset:0
    ds_write_b16_d16_hi v115, v26 offset:16
    ds_write_b16 v115, v27 offset:32
    ds_write_b16_d16_hi v115, v27 offset:48
    s_waitcnt lgkmcnt(0)
    s_barrier
    ds_read_b128 v[16:19], v126 offset:16
    ds_read_b64 v[20:21], v126 offset:8
    ds_read_b32 v22, v126 offset:32
    ds_write_b32 v113, v104
    s_waitcnt lgkmcnt(3)
    v_cndmask_b32 v17, v17, v16, s[56:57]
    v_cndmask_b32 v18, v18, v16, s[62:63]
    v_perm_b32 v24, v16, v16, v122
    v_perm_b32 v25, v18, v17, v123
    s_waitcnt lgkmcnt(1)
    v_perm_b32 v26, v22, v18, v124
    v_perm_b32 v27, v22, v19, v125
    v_perm_b32 v28, v16, v21, v121
    v_perm_b32 v23, v16, v20, v120
    ds_write_b128 v127, v[24:27]
    v_mov_b32 v29, v24
    v_mov_b32 v30, v25
    v_mov_b32_e64 v31, v26
    ds_write_b128 v127, v[28:31] offset:8320
    v_alignbit_b32 v32, v24, v28, 16
    v_alignbit_b32 v33, v25, v24, 16
    v_alignbit_b32 v34, v26, v25, 16
    v_alignbit_b32 v35, v27, v26, 16
    ds_write_b128 v127, v[32:35] offset:4160
    v_alignbit_b32 v36, v28, v23, 16
    v_mov_b32 v37, v32
    v_mov_b32 v38, v33
    v_mov_b32 v39, v34
    ds_write_b128 v127, v[36:39] offset:12480
    s_lshl_b32 s53, s58, 13
    s_add_u32 s53, s53, 9437184
    v_lshlrev_b32 v126, 4, v0
    s_cmp_lg_u32 s3, 0
    s_cbranch_scc1 A_S1
    s_and_b32 s5, s2, 7
    s_mul_i32 s5, s5, 1280
    s_mov_b32 s6, 65536
    s_add_u32 s98, s5, 2342912
LPOLL7:
    buffer_load_dwordx4 v[60:63], v2, s[12:15], s98 offen sc1
    s_waitcnt vmcnt(0)
    v_xor_b32 v60, s96, v60
    v_xor_b32 v61, s96, v61
    v_xor_b32 v62, s96, v62
    v_xor_b32 v63, s96, v63
    v_or3_b32 v60, v60, v61, v62
    v_or_b32 v60, v60, v63
    v_cmp_ne_u32 vcc, 0, v60
    s_sub_u32 s6, s6, 1
    s_cbranch_scc1 LPOLX7
    s_cbranch_vccz LPOLX7
    s_sleep 4
    s_branch LPOLL7
LPOLX7:
A_S1:
    s_barrier
    buffer_load_dwordx4 v[96:99], v8, s[12:15], s28 offen sc1
    buffer_load_dwordx4 v[100:103], v8, s[12:15], s29 offen sc1
    s_waitcnt vmcnt(1)
    ds_write_b128 v119, v[96:99]
    s_waitcnt vmcnt(0)
    ds_write_b128 v119, v[100:103] offset:128
    s_waitcnt lgkmcnt(0)
    s_barrier
    s_nop 0
    ds_read_b64_tr_b16 v[16:17], v112 offset:8
    ds_read_b64_tr_b16 v[18:19], v112 offset:0
    ds_read_b128 v[32:35], v117 offset:256
    ds_read_b128 v[36:39], v117 offset:512
    ds_read_b128 v[40:43], v117 offset:768
    ds_read_b128 v[44:47], v117 offset:1024
    ds_read_b64_tr_b16 v[20:21], v112 offset:1032
    ds_read_b64_tr_b16 v[22:23], v112 offset:1024
    ds_read_b64_tr_b16 v[24:25], v112 offset:2056
    ds_read_b64_tr_b16 v[26:27], v112 offset:2048
    ds_read_b64_tr_b16 v[28:29], v112 offset:3080
    ds_read_b64_tr_b16 v[30:31], v112 offset:3072
    s_waitcnt lgkmcnt(9)
    v_mfma_f32_16x16x32_bf16 v[80:83], v[16:19], v[32:35], 0
    ds_read_b64_tr_b16 v[48:49], v112 offset:72
    s_waitcnt lgkmcnt(7)
    v_mfma_f32_16x16x32_bf16 v[84:87], v[16:19], v[36:39], 0
    ds_read_b64_tr_b16 v[50:51], v112 offset:64
    ds_read_b128 v[64:67], v117 offset:240
    v_mfma_f32_16x16x32_bf16 v[88:91], v[16:19], v[40:43], 0
    ds_read_b128 v[68:71], v117 offset:496
    v_mfma_f32_16x16x32_bf16 v[92:95], v[16:19], v[44:47], 0
    ds_read_b128 v[72:75], v117 offset:752
    s_waitcnt lgkmcnt(7)
    s_nop 0
    v_mfma_f32_16x16x32_bf16 v[84:87], v[20:23], v[32:35], v[84:87]
    ds_read_b128 v[76:79], v117 offset:1008
    v_mfma_f32_16x16x32_bf16 v[88:91], v[20:23], v[36:39], v[88:91]
    ds_read_b64_tr_b16 v[52:53], v112 offset:1096
    ds_read_b64_tr_b16 v[54:55], v112 offset:1088
    v_mfma_f32_16x16x32_bf16 v[92:95], v[20:23], v[40:43], v[92:95]
    ds_read_b64_tr_b16 v[56:57], v112 offset:2120
    v_mfma_f32_16x16x32_bf16 v[88:91], v[24:27], v[32:35], v[88:91]
    ds_read_b64_tr_b16 v[58:59], v112 offset:2112
    v_mfma_f32_16x16x32_bf16 v[92:95], v[24:27], v[36:39], v[92:95]
    ds_read_b64_tr_b16 v[60:61], v112 offset:3144
    s_waitcnt lgkmcnt(11)
    v_mfma_f32_16x16x32_bf16 v[92:95], v[28:31], v[32:35], v[92:95]
    ds_read_b64_tr_b16 v[62:63], v112 offset:3136
    s_waitcnt lgkmcnt(6)
    v_mfma_f32_16x16x32_bf16 v[80:83], v[48:51], v[64:67], v[80:83]
    ds_read_b64_tr_b16 v[16:17], v112 offset:136
    v_mfma_f32_16x16x32_bf16 v[84:87], v[48:51], v[68:71], v[84:87]
    ds_read_b64_tr_b16 v[18:19], v112 offset:128
    ds_read_b128 v[32:35], v117 offset:224
    v_mfma_f32_16x16x32_bf16 v[88:91], v[48:51], v[72:75], v[88:91]
    ds_read_b128 v[36:39], v117 offset:480
    v_mfma_f32_16x16x32_bf16 v[92:95], v[48:51], v[76:79], v[92:95]
    ds_read_b128 v[40:43], v117 offset:736
    s_waitcnt lgkmcnt(7)
    s_nop 0
    v_mfma_f32_16x16x32_bf16 v[84:87], v[52:55], v[64:67], v[84:87]
    ds_read_b128 v[44:47], v117 offset:992
    v_mfma_f32_16x16x32_bf16 v[88:91], v[52:55], v[68:71], v[88:91]
    ds_read_b64_tr_b16 v[20:21], v112 offset:1160
    ds_read_b64_tr_b16 v[22:23], v112 offset:1152
    v_mfma_f32_16x16x32_bf16 v[92:95], v[52:55], v[72:75], v[92:95]
    ds_read_b64_tr_b16 v[24:25], v112 offset:2184
    v_mfma_f32_16x16x32_bf16 v[88:91], v[56:59], v[64:67], v[88:91]
    ds_read_b64_tr_b16 v[26:27], v112 offset:2176
    v_mfma_f32_16x16x32_bf16 v[92:95], v[56:59], v[68:71], v[92:95]
    ds_read_b64_tr_b16 v[28:29], v112 offset:3208
    s_waitcnt lgkmcnt(11)
    v_mfma_f32_16x16x32_bf16 v[92:95], v[60:63], v[64:67], v[92:95]
    ds_read_b64_tr_b16 v[30:31], v112 offset:3200
    s_waitcnt lgkmcnt(6)
    v_mfma_f32_16x16x32_bf16 v[80:83], v[16:19], v[32:35], v[80:83]
    ds_read_b64_tr_b16 v[48:49], v112 offset:200
    v_mfma_f32_16x16x32_bf16 v[84:87], v[16:19], v[36:39], v[84:87]
    ds_read_b64_tr_b16 v[50:51], v112 offset:192
    ds_read_b128 v[64:67], v117 offset:208
    v_mfma_f32_16x16x32_bf16 v[88:91], v[16:19], v[40:43], v[88:91]
    ds_read_b128 v[68:71], v117 offset:464
    v_mfma_f32_16x16x32_bf16 v[92:95], v[16:19], v[44:47], v[92:95]
    ds_read_b128 v[72:75], v117 offset:720
    s_waitcnt lgkmcnt(7)
    s_nop 0
    v_mfma_f32_16x16x32_bf16 v[84:87], v[20:23], v[32:35], v[84:87]
    ds_read_b128 v[76:79], v117 offset:976
    v_mfma_f32_16x16x32_bf16 v[88:91], v[20:23], v[36:39], v[88:91]
    ds_read_b64_tr_b16 v[52:53], v112 offset:1224
    ds_read_b64_tr_b16 v[54:55], v112 offset:1216
    v_mfma_f32_16x16x32_bf16 v[92:95], v[20:23], v[40:43], v[92:95]
    ds_read_b64_tr_b16 v[56:57], v112 offset:2248
    v_mfma_f32_16x16x32_bf16 v[88:91], v[24:27], v[32:35], v[88:91]
    ds_read_b64_tr_b16 v[58:59], v112 offset:2240
    v_mfma_f32_16x16x32_bf16 v[92:95], v[24:27], v[36:39], v[92:95]
    ds_read_b64_tr_b16 v[60:61], v112 offset:3272
    s_waitcnt lgkmcnt(11)
    v_mfma_f32_16x16x32_bf16 v[92:95], v[28:31], v[32:35], v[92:95]
    ds_read_b64_tr_b16 v[62:63], v112 offset:3264
    s_waitcnt lgkmcnt(6)
    v_mfma_f32_16x16x32_bf16 v[80:83], v[48:51], v[64:67], v[80:83]
    ds_read_b64_tr_b16 v[16:17], v112 offset:264
    v_mfma_f32_16x16x32_bf16 v[84:87], v[48:51], v[68:71], v[84:87]
    ds_read_b64_tr_b16 v[18:19], v112 offset:256
    ds_read_b128 v[32:35], v117 offset:192
    v_mfma_f32_16x16x32_bf16 v[88:91], v[48:51], v[72:75], v[88:91]
    ds_read_b128 v[36:39], v117 offset:448
    v_mfma_f32_16x16x32_bf16 v[92:95], v[48:51], v[76:79], v[92:95]
    ds_read_b128 v[40:43], v117 offset:704
    s_waitcnt lgkmcnt(7)
    s_nop 0
    v_mfma_f32_16x16x32_bf16 v[84:87], v[52:55], v[64:67], v[84:87]
    ds_read_b128 v[44:47], v117 offset:960
    v_mfma_f32_16x16x32_bf16 v[88:91], v[52:55], v[68:71], v[88:91]
    ds_read_b64_tr_b16 v[20:21], v112 offset:1288
    ds_read_b64_tr_b16 v[22:23], v112 offset:1280
    v_mfma_f32_16x16x32_bf16 v[92:95], v[52:55], v[72:75], v[92:95]
    ds_read_b64_tr_b16 v[24:25], v112 offset:2312
    v_mfma_f32_16x16x32_bf16 v[88:91], v[56:59], v[64:67], v[88:91]
    ds_read_b64_tr_b16 v[26:27], v112 offset:2304
    v_mfma_f32_16x16x32_bf16 v[92:95], v[56:59], v[68:71], v[92:95]
    ds_read_b64_tr_b16 v[28:29], v112 offset:3336
    s_waitcnt lgkmcnt(11)
    v_mfma_f32_16x16x32_bf16 v[92:95], v[60:63], v[64:67], v[92:95]
    ds_read_b64_tr_b16 v[30:31], v112 offset:3328
    s_waitcnt lgkmcnt(6)
    v_mfma_f32_16x16x32_bf16 v[80:83], v[16:19], v[32:35], v[80:83]
    ds_read_b64_tr_b16 v[48:49], v112 offset:328
    v_mfma_f32_16x16x32_bf16 v[84:87], v[16:19], v[36:39], v[84:87]
    ds_read_b64_tr_b16 v[50:51], v112 offset:320
    ds_read_b128 v[64:67], v117 offset:176
    v_mfma_f32_16x16x32_bf16 v[88:91], v[16:19], v[40:43], v[88:91]
    ds_read_b128 v[68:71], v117 offset:432
    v_mfma_f32_16x16x32_bf16 v[92:95], v[16:19], v[44:47], v[92:95]
    ds_read_b128 v[72:75], v117 offset:688
    s_waitcnt lgkmcnt(7)
    s_nop 0
    v_mfma_f32_16x16x32_bf16 v[84:87], v[20:23], v[32:35], v[84:87]
    ds_read_b128 v[76:79], v117 offset:944
    v_mfma_f32_16x16x32_bf16 v[88:91], v[20:23], v[36:39], v[88:91]
    ds_read_b64_tr_b16 v[52:53], v112 offset:1352
    ds_read_b64_tr_b16 v[54:55], v112 offset:1344
    v_mfma_f32_16x16x32_bf16 v[92:95], v[20:23], v[40:43], v[92:95]
    ds_read_b64_tr_b16 v[56:57], v112 offset:2376
    v_mfma_f32_16x16x32_bf16 v[88:91], v[24:27], v[32:35], v[88:91]
    ds_read_b64_tr_b16 v[58:59], v112 offset:2368
    v_mfma_f32_16x16x32_bf16 v[92:95], v[24:27], v[36:39], v[92:95]
    ds_read_b64_tr_b16 v[60:61], v112 offset:3400
    s_waitcnt lgkmcnt(11)
    v_mfma_f32_16x16x32_bf16 v[92:95], v[28:31], v[32:35], v[92:95]
    ds_read_b64_tr_b16 v[62:63], v112 offset:3392
    s_waitcnt lgkmcnt(6)
    v_mfma_f32_16x16x32_bf16 v[80:83], v[48:51], v[64:67], v[80:83]
    ds_read_b64_tr_b16 v[16:17], v112 offset:392
    v_mfma_f32_16x16x32_bf16 v[84:87], v[48:51], v[68:71], v[84:87]
    ds_read_b64_tr_b16 v[18:19], v112 offset:384
    ds_read_b128 v[32:35], v117 offset:160
    v_mfma_f32_16x16x32_bf16 v[88:91], v[48:51], v[72:75], v[88:91]
    ds_read_b128 v[36:39], v117 offset:416
    v_mfma_f32_16x16x32_bf16 v[92:95], v[48:51], v[76:79], v[92:95]
    ds_read_b128 v[40:43], v117 offset:672
    s_waitcnt lgkmcnt(7)
    s_nop 0
    v_mfma_f32_16x16x32_bf16 v[84:87], v[52:55], v[64:67], v[84:87]
    ds_read_b128 v[44:47], v117 offset:928
    v_mfma_f32_16x16x32_bf16 v[88:91], v[52:55], v[68:71], v[88:91]
    ds_read_b64_tr_b16 v[20:21], v112 offset:1416
    ds_read_b64_tr_b16 v[22:23], v112 offset:1408
    v_mfma_f32_16x16x32_bf16 v[92:95], v[52:55], v[72:75], v[92:95]
    ds_read_b64_tr_b16 v[24:25], v112 offset:2440
    v_mfma_f32_16x16x32_bf16 v[88:91], v[56:59], v[64:67], v[88:91]
    ds_read_b64_tr_b16 v[26:27], v112 offset:2432
    v_mfma_f32_16x16x32_bf16 v[92:95], v[56:59], v[68:71], v[92:95]
    ds_read_b64_tr_b16 v[28:29], v112 offset:3464
    s_waitcnt lgkmcnt(11)
    v_mfma_f32_16x16x32_bf16 v[92:95], v[60:63], v[64:67], v[92:95]
    ds_read_b64_tr_b16 v[30:31], v112 offset:3456
    s_waitcnt lgkmcnt(6)
    v_mfma_f32_16x16x32_bf16 v[80:83], v[16:19], v[32:35], v[80:83]
    ds_read_b64_tr_b16 v[48:49], v112 offset:456
    v_mfma_f32_16x16x32_bf16 v[84:87], v[16:19], v[36:39], v[84:87]
    ds_read_b64_tr_b16 v[50:51], v112 offset:448
    ds_read_b128 v[64:67], v117 offset:144
    v_mfma_f32_16x16x32_bf16 v[88:91], v[16:19], v[40:43], v[88:91]
    ds_read_b128 v[68:71], v117 offset:400
    v_mfma_f32_16x16x32_bf16 v[92:95], v[16:19], v[44:47], v[92:95]
    ds_read_b128 v[72:75], v117 offset:656
    s_waitcnt lgkmcnt(7)
    s_nop 0
    v_mfma_f32_16x16x32_bf16 v[84:87], v[20:23], v[32:35], v[84:87]
    ds_read_b128 v[76:79], v117 offset:912
    v_mfma_f32_16x16x32_bf16 v[88:91], v[20:23], v[36:39], v[88:91]
    ds_read_b64_tr_b16 v[52:53], v112 offset:1480
    ds_read_b64_tr_b16 v[54:55], v112 offset:1472
    v_mfma_f32_16x16x32_bf16 v[92:95], v[20:23], v[40:43], v[92:95]
    ds_read_b64_tr_b16 v[56:57], v112 offset:2504
    v_mfma_f32_16x16x32_bf16 v[88:91], v[24:27], v[32:35], v[88:91]
    ds_read_b64_tr_b16 v[58:59], v112 offset:2496
    v_mfma_f32_16x16x32_bf16 v[92:95], v[24:27], v[36:39], v[92:95]
    ds_read_b64_tr_b16 v[60:61], v112 offset:3528
    s_waitcnt lgkmcnt(11)
    v_mfma_f32_16x16x32_bf16 v[92:95], v[28:31], v[32:35], v[92:95]
    ds_read_b64_tr_b16 v[62:63], v112 offset:3520
    s_waitcnt lgkmcnt(6)
    v_mfma_f32_16x16x32_bf16 v[80:83], v[48:51], v[64:67], v[80:83]
    ds_read_b64_tr_b16 v[16:17], v112 offset:520
    v_mfma_f32_16x16x32_bf16 v[84:87], v[48:51], v[68:71], v[84:87]
    ds_read_b64_tr_b16 v[18:19], v112 offset:512
    ds_read_b128 v[32:35], v117 offset:128
    v_mfma_f32_16x16x32_bf16 v[88:91], v[48:51], v[72:75], v[88:91]
    ds_read_b128 v[36:39], v117 offset:384
    v_mfma_f32_16x16x32_bf16 v[92:95], v[48:51], v[76:79], v[92:95]
    ds_read_b128 v[40:43], v117 offset:640
    s_waitcnt lgkmcnt(7)
    s_nop 0
    v_mfma_f32_16x16x32_bf16 v[84:87], v[52:55], v[64:67], v[84:87]
    ds_read_b128 v[44:47], v117 offset:896
    v_mfma_f32_16x16x32_bf16 v[88:91], v[52:55], v[68:71], v[88:91]
    ds_read_b64_tr_b16 v[20:21], v112 offset:1544
    ds_read_b64_tr_b16 v[22:23], v112 offset:1536
    v_mfma_f32_16x16x32_bf16 v[92:95], v[52:55], v[72:75], v[92:95]
    ds_read_b64_tr_b16 v[24:25], v112 offset:2568
    v_mfma_f32_16x16x32_bf16 v[88:91], v[56:59], v[64:67], v[88:91]
    ds_read_b64_tr_b16 v[26:27], v112 offset:2560
    v_mfma_f32_16x16x32_bf16 v[92:95], v[56:59], v[68:71], v[92:95]
    ds_read_b64_tr_b16 v[28:29], v112 offset:3592
    s_waitcnt lgkmcnt(11)
    v_mfma_f32_16x16x32_bf16 v[92:95], v[60:63], v[64:67], v[92:95]
    ds_read_b64_tr_b16 v[30:31], v112 offset:3584
    s_waitcnt lgkmcnt(6)
    v_mfma_f32_16x16x32_bf16 v[80:83], v[16:19], v[32:35], v[80:83]
    ds_read_b64_tr_b16 v[48:49], v112 offset:584
    v_mfma_f32_16x16x32_bf16 v[84:87], v[16:19], v[36:39], v[84:87]
    ds_read_b64_tr_b16 v[50:51], v112 offset:576
    ds_read_b128 v[64:67], v117 offset:112
    v_mfma_f32_16x16x32_bf16 v[88:91], v[16:19], v[40:43], v[88:91]
    ds_read_b128 v[68:71], v117 offset:368
    v_mfma_f32_16x16x32_bf16 v[92:95], v[16:19], v[44:47], v[92:95]
    ds_read_b128 v[72:75], v117 offset:624
    s_waitcnt lgkmcnt(7)
    s_nop 0
    v_mfma_f32_16x16x32_bf16 v[84:87], v[20:23], v[32:35], v[84:87]
    ds_read_b128 v[76:79], v117 offset:880
    v_mfma_f32_16x16x32_bf16 v[88:91], v[20:23], v[36:39], v[88:91]
    ds_read_b64_tr_b16 v[52:53], v112 offset:1608
    ds_read_b64_tr_b16 v[54:55], v112 offset:1600
    v_mfma_f32_16x16x32_bf16 v[92:95], v[20:23], v[40:43], v[92:95]
    ds_read_b64_tr_b16 v[56:57], v112 offset:2632
    v_mfma_f32_16x16x32_bf16 v[88:91], v[24:27], v[32:35], v[88:91]
    ds_read_b64_tr_b16 v[58:59], v112 offset:2624
    v_mfma_f32_16x16x32_bf16 v[92:95], v[24:27], v[36:39], v[92:95]
    ds_read_b64_tr_b16 v[60:61], v112 offset:3656
    s_waitcnt lgkmcnt(11)
    v_mfma_f32_16x16x32_bf16 v[92:95], v[28:31], v[32:35], v[92:95]
    ds_read_b64_tr_b16 v[62:63], v112 offset:3648
    s_waitcnt lgkmcnt(6)
    v_mfma_f32_16x16x32_bf16 v[80:83], v[48:51], v[64:67], v[80:83]
    ds_read_b64_tr_b16 v[16:17], v112 offset:648
    v_mfma_f32_16x16x32_bf16 v[84:87], v[48:51], v[68:71], v[84:87]
    ds_read_b64_tr_b16 v[18:19], v112 offset:640
    ds_read_b128 v[32:35], v117 offset:96
    v_mfma_f32_16x16x32_bf16 v[88:91], v[48:51], v[72:75], v[88:91]
    ds_read_b128 v[36:39], v117 offset:352
    v_mfma_f32_16x16x32_bf16 v[92:95], v[48:51], v[76:79], v[92:95]
    ds_read_b128 v[40:43], v117 offset:608
    s_waitcnt lgkmcnt(7)
    s_nop 0
    v_mfma_f32_16x16x32_bf16 v[84:87], v[52:55], v[64:67], v[84:87]
    ds_read_b128 v[44:47], v117 offset:864
    v_mfma_f32_16x16x32_bf16 v[88:91], v[52:55], v[68:71], v[88:91]
    ds_read_b64_tr_b16 v[20:21], v112 offset:1672
    ds_read_b64_tr_b16 v[22:23], v112 offset:1664
    v_mfma_f32_16x16x32_bf16 v[92:95], v[52:55], v[72:75], v[92:95]
    ds_read_b64_tr_b16 v[24:25], v112 offset:2696
    v_mfma_f32_16x16x32_bf16 v[88:91], v[56:59], v[64:67], v[88:91]
    ds_read_b64_tr_b16 v[26:27], v112 offset:2688
    v_mfma_f32_16x16x32_bf16 v[92:95], v[56:59], v[68:71], v[92:95]
    ds_read_b64_tr_b16 v[28:29], v112 offset:3720
    s_waitcnt lgkmcnt(11)
    v_mfma_f32_16x16x32_bf16 v[92:95], v[60:63], v[64:67], v[92:95]
    ds_read_b64_tr_b16 v[30:31], v112 offset:3712
    s_waitcnt lgkmcnt(6)
    v_mfma_f32_16x16x32_bf16 v[80:83], v[16:19], v[32:35], v[80:83]
    ds_read_b64_tr_b16 v[48:49], v112 offset:712
    v_mfma_f32_16x16x32_bf16 v[84:87], v[16:19], v[36:39], v[84:87]
    ds_read_b64_tr_b16 v[50:51], v112 offset:704
    ds_read_b128 v[64:67], v117 offset:80
    v_mfma_f32_16x16x32_bf16 v[88:91], v[16:19], v[40:43], v[88:91]
    ds_read_b128 v[68:71], v117 offset:336
    v_mfma_f32_16x16x32_bf16 v[92:95], v[16:19], v[44:47], v[92:95]
    ds_read_b128 v[72:75], v117 offset:592
    s_waitcnt lgkmcnt(7)
    s_nop 0
    v_mfma_f32_16x16x32_bf16 v[84:87], v[20:23], v[32:35], v[84:87]
    ds_read_b128 v[76:79], v117 offset:848
    v_mfma_f32_16x16x32_bf16 v[88:91], v[20:23], v[36:39], v[88:91]
    ds_read_b64_tr_b16 v[52:53], v112 offset:1736
    ds_read_b64_tr_b16 v[54:55], v112 offset:1728
    v_mfma_f32_16x16x32_bf16 v[92:95], v[20:23], v[40:43], v[92:95]
    ds_read_b64_tr_b16 v[56:57], v112 offset:2760
    v_mfma_f32_16x16x32_bf16 v[88:91], v[24:27], v[32:35], v[88:91]
    ds_read_b64_tr_b16 v[58:59], v112 offset:2752
    v_mfma_f32_16x16x32_bf16 v[92:95], v[24:27], v[36:39], v[92:95]
    ds_read_b64_tr_b16 v[60:61], v112 offset:3784
    s_waitcnt lgkmcnt(11)
    v_mfma_f32_16x16x32_bf16 v[92:95], v[28:31], v[32:35], v[92:95]
    ds_read_b64_tr_b16 v[62:63], v112 offset:3776
    s_waitcnt lgkmcnt(6)
    v_mfma_f32_16x16x32_bf16 v[80:83], v[48:51], v[64:67], v[80:83]
    ds_read_b64_tr_b16 v[16:17], v112 offset:776
    v_mfma_f32_16x16x32_bf16 v[84:87], v[48:51], v[68:71], v[84:87]
    ds_read_b64_tr_b16 v[18:19], v112 offset:768
    ds_read_b128 v[32:35], v117 offset:64
    v_mfma_f32_16x16x32_bf16 v[88:91], v[48:51], v[72:75], v[88:91]
    ds_read_b128 v[36:39], v117 offset:320
    v_mfma_f32_16x16x32_bf16 v[92:95], v[48:51], v[76:79], v[92:95]
    ds_read_b128 v[40:43], v117 offset:576
    s_waitcnt lgkmcnt(7)
    s_nop 0
    v_mfma_f32_16x16x32_bf16 v[84:87], v[52:55], v[64:67], v[84:87]
    ds_read_b128 v[44:47], v117 offset:832
    v_mfma_f32_16x16x32_bf16 v[88:91], v[52:55], v[68:71], v[88:91]
    ds_read_b64_tr_b16 v[20:21], v112 offset:1800
    ds_read_b64_tr_b16 v[22:23], v112 offset:1792
    v_mfma_f32_16x16x32_bf16 v[92:95], v[52:55], v[72:75], v[92:95]
    ds_read_b64_tr_b16 v[24:25], v112 offset:2824
    v_mfma_f32_16x16x32_bf16 v[88:91], v[56:59], v[64:67], v[88:91]
    ds_read_b64_tr_b16 v[26:27], v112 offset:2816
    v_mfma_f32_16x16x32_bf16 v[92:95], v[56:59], v[68:71], v[92:95]
    ds_read_b64_tr_b16 v[28:29], v112 offset:3848
    s_waitcnt lgkmcnt(11)
    v_mfma_f32_16x16x32_bf16 v[92:95], v[60:63], v[64:67], v[92:95]
    ds_read_b64_tr_b16 v[30:31], v112 offset:3840
    s_waitcnt lgkmcnt(6)
    v_mfma_f32_16x16x32_bf16 v[80:83], v[16:19], v[32:35], v[80:83]
    ds_read_b64_tr_b16 v[48:49], v112 offset:840
    v_mfma_f32_16x16x32_bf16 v[84:87], v[16:19], v[36:39], v[84:87]
    ds_read_b64_tr_b16 v[50:51], v112 offset:832
    ds_read_b128 v[64:67], v117 offset:48
    v_mfma_f32_16x16x32_bf16 v[88:91], v[16:19], v[40:43], v[88:91]
    ds_read_b128 v[68:71], v117 offset:304
    v_mfma_f32_16x16x32_bf16 v[92:95], v[16:19], v[44:47], v[92:95]
    ds_read_b128 v[72:75], v117 offset:560
    s_waitcnt lgkmcnt(7)
    s_nop 0
    v_mfma_f32_16x16x32_bf16 v[84:87], v[20:23], v[32:35], v[84:87]
    ds_read_b128 v[76:79], v117 offset:816
    v_mfma_f32_16x16x32_bf16 v[88:91], v[20:23], v[36:39], v[88:91]
    ds_read_b64_tr_b16 v[52:53], v112 offset:1864
    ds_read_b64_tr_b16 v[54:55], v112 offset:1856
    v_mfma_f32_16x16x32_bf16 v[92:95], v[20:23], v[40:43], v[92:95]
    ds_read_b64_tr_b16 v[56:57], v112 offset:2888
    v_mfma_f32_16x16x32_bf16 v[88:91], v[24:27], v[32:35], v[88:91]
    ds_read_b64_tr_b16 v[58:59], v112 offset:2880
    v_mfma_f32_16x16x32_bf16 v[92:95], v[24:27], v[36:39], v[92:95]
    ds_read_b64_tr_b16 v[60:61], v112 offset:3912
    s_waitcnt lgkmcnt(11)
    v_mfma_f32_16x16x32_bf16 v[92:95], v[28:31], v[32:35], v[92:95]
    ds_read_b64_tr_b16 v[62:63], v112 offset:3904
    s_waitcnt lgkmcnt(6)
    v_mfma_f32_16x16x32_bf16 v[80:83], v[48:51], v[64:67], v[80:83]
    ds_read_b64_tr_b16 v[16:17], v112 offset:904
    v_mfma_f32_16x16x32_bf16 v[84:87], v[48:51], v[68:71], v[84:87]
    ds_read_b64_tr_b16 v[18:19], v112 offset:896
    ds_read_b128 v[32:35], v117 offset:32
    v_mfma_f32_16x16x32_bf16 v[88:91], v[48:51], v[72:75], v[88:91]
    ds_read_b128 v[36:39], v117 offset:288
    v_mfma_f32_16x16x32_bf16 v[92:95], v[48:51], v[76:79], v[92:95]
    ds_read_b128 v[40:43], v117 offset:544
    s_waitcnt lgkmcnt(7)
    s_nop 0
    v_mfma_f32_16x16x32_bf16 v[84:87], v[52:55], v[64:67], v[84:87]
    ds_read_b128 v[44:47], v117 offset:800
    v_mfma_f32_16x16x32_bf16 v[88:91], v[52:55], v[68:71], v[88:91]
    ds_read_b64_tr_b16 v[20:21], v112 offset:1928
    ds_read_b64_tr_b16 v[22:23], v112 offset:1920
    v_mfma_f32_16x16x32_bf16 v[92:95], v[52:55], v[72:75], v[92:95]
    ds_read_b64_tr_b16 v[24:25], v112 offset:2952
    v_mfma_f32_16x16x32_bf16 v[88:91], v[56:59], v[64:67], v[88:91]
    ds_read_b64_tr_b16 v[26:27], v112 offset:2944
    v_mfma_f32_16x16x32_bf16 v[92:95], v[56:59], v[68:71], v[92:95]
    ds_read_b64_tr_b16 v[28:29], v112 offset:3976
    s_waitcnt lgkmcnt(11)
    v_mfma_f32_16x16x32_bf16 v[92:95], v[60:63], v[64:67], v[92:95]
    ds_read_b64_tr_b16 v[30:31], v112 offset:3968
    s_waitcnt lgkmcnt(6)
    v_mfma_f32_16x16x32_bf16 v[80:83], v[16:19], v[32:35], v[80:83]
    ds_read_b64_tr_b16 v[48:49], v112 offset:968
    v_mfma_f32_16x16x32_bf16 v[84:87], v[16:19], v[36:39], v[84:87]
    ds_read_b64_tr_b16 v[50:51], v112 offset:960
    ds_read_b128 v[64:67], v117 offset:16
    v_mfma_f32_16x16x32_bf16 v[88:91], v[16:19], v[40:43], v[88:91]
    ds_read_b128 v[68:71], v117 offset:272
    v_mfma_f32_16x16x32_bf16 v[92:95], v[16:19], v[44:47], v[92:95]
    ds_read_b128 v[72:75], v117 offset:528
    s_waitcnt lgkmcnt(7)
    s_nop 0
    v_mfma_f32_16x16x32_bf16 v[84:87], v[20:23], v[32:35], v[84:87]
    ds_read_b128 v[76:79], v117 offset:784
    v_mfma_f32_16x16x32_bf16 v[88:91], v[20:23], v[36:39], v[88:91]
    ds_read_b64_tr_b16 v[52:53], v112 offset:1992
    ds_read_b64_tr_b16 v[54:55], v112 offset:1984
    v_mfma_f32_16x16x32_bf16 v[92:95], v[20:23], v[40:43], v[92:95]
    ds_read_b64_tr_b16 v[56:57], v112 offset:3016
    v_mfma_f32_16x16x32_bf16 v[88:91], v[24:27], v[32:35], v[88:91]
    ds_read_b64_tr_b16 v[58:59], v112 offset:3008
    v_mfma_f32_16x16x32_bf16 v[92:95], v[24:27], v[36:39], v[92:95]
    ds_read_b64_tr_b16 v[60:61], v112 offset:4040
    s_waitcnt lgkmcnt(11)
    v_mfma_f32_16x16x32_bf16 v[92:95], v[28:31], v[32:35], v[92:95]
    ds_read_b64_tr_b16 v[62:63], v112 offset:4032
    s_waitcnt lgkmcnt(6)
    v_mfma_f32_16x16x32_bf16 v[80:83], v[48:51], v[64:67], v[80:83]
    v_mfma_f32_16x16x32_bf16 v[84:87], v[48:51], v[68:71], v[84:87]
    v_mfma_f32_16x16x32_bf16 v[88:91], v[48:51], v[72:75], v[88:91]
    v_mfma_f32_16x16x32_bf16 v[92:95], v[48:51], v[76:79], v[92:95]
    s_waitcnt lgkmcnt(2)
    v_mfma_f32_16x16x32_bf16 v[84:87], v[52:55], v[64:67], v[84:87]
    v_mfma_f32_16x16x32_bf16 v[88:91], v[52:55], v[68:71], v[88:91]
    v_mfma_f32_16x16x32_bf16 v[92:95], v[52:55], v[72:75], v[92:95]
    v_mfma_f32_16x16x32_bf16 v[88:91], v[56:59], v[64:67], v[88:91]
    v_mfma_f32_16x16x32_bf16 v[92:95], v[56:59], v[68:71], v[92:95]
    s_waitcnt lgkmcnt(0)
    v_mfma_f32_16x16x32_bf16 v[92:95], v[60:63], v[64:67], v[92:95]
    s_add_u32 s55, s53, 4096
    v_cvt_pk_bf16_f32 v96, v80, v81
    v_cvt_pk_bf16_f32 v97, v82, v83
    ds_write_b64 v116, v[96:97] offset:0
    v_cvt_pk_bf16_f32 v98, v84, v85
    v_cvt_pk_bf16_f32 v99, v86, v87
    ds_write_b64 v116, v[98:99] offset:1152
    v_cvt_pk_bf16_f32 v100, v88, v89
    v_cvt_pk_bf16_f32 v101, v90, v91
    ds_write_b64 v116, v[100:101] offset:2368
    v_cvt_pk_bf16_f32 v102, v92, v93
    v_cvt_pk_bf16_f32 v103, v94, v95
    ds_write_b64 v116, v[102:103] offset:3520
    s_waitcnt lgkmcnt(0)
    s_barrier
    ds_read_u16 v16, v118 offset:0
    ds_read_u16 v20, v118 offset:4672
    ds_read_u16 v17, v118 offset:576
    ds_read_u16 v21, v118 offset:5248
    ds_read_u16 v18, v118 offset:1152
    ds_read_u16 v22, v118 offset:5824
    ds_read_u16 v19, v118 offset:1728
    ds_read_u16 v23, v118 offset:6400
    s_waitcnt lgkmcnt(7)
    ds_read_u16 v24, v118 offset:288
    ds_read_u16 v28, v118 offset:4960
    ds_read_u16 v25, v118 offset:864
    ds_read_u16 v29, v118 offset:5536
    ds_read_u16 v26, v118 offset:1440
    ds_read_u16 v30, v118 offset:6112
    ds_read_u16 v27, v118 offset:2016
    ds_read_u16 v31, v118 offset:6688
    s_waitcnt lgkmcnt(14)
    v_perm_b32 v32, v20, v16, s59
    s_waitcnt lgkmcnt(12)
    v_perm_b32 v33, v21, v17, s59
    s_waitcnt lgkmcnt(10)
    v_perm_b32 v34, v22, v18, s59
    s_waitcnt lgkmcnt(8)
    v_perm_b32 v35, v23, v19, s59
    buffer_store_dwordx4 v[32:35], v126, s[12:15], s53 offen sc1
    s_waitcnt lgkmcnt(6)
    v_perm_b32 v36, v28, v24, s59
    s_waitcnt lgkmcnt(4)
    v_perm_b32 v37, v29, v25, s59
    s_waitcnt lgkmcnt(2)
    v_perm_b32 v38, v30, v26, s59
    s_waitcnt lgkmcnt(0)
    v_perm_b32 v39, v31, v27, s59
    buffer_store_dwordx4 v[36:39], v126, s[12:15], s55 offen sc1
    s_endpgm
A_B:
    s_cmp_lg_u32 s58, 0
    s_cbranch_scc1 A_B1
    s_lshl_b32 s22, s3, 11
    s_add_u32 s22, s22, 2187264
    v_mov_b32 v40, -1
    v_mov_b32 v41, -1
    v_mov_b32 v42, -1
    v_mov_b32 v43, -1
    buffer_store_dwordx4 v[40:43], v2, s[12:15], s22 offen sc1
    buffer_store_dwordx4 v[40:43], v2, s[12:15], s22 offen offset:1024 sc1
A_B1:
    s_mul_i32 s53, s26, 11424
    s_add_u32 s53, s53, s54
    s_add_u32 m0, s53, 34816
    s_waitcnt vmcnt(0)
    global_load_dwordx4 v[120:123], v6, s[20:21] offset:1024
    global_load_dwordx2 v[124:125], v6, s[20:21] offset:1040
    v_lshlrev_b32 v11, 16, v11
    v_lshlrev_b32 v12, 16, v12
    v_lshlrev_b32 v18, 16, v18
    v_lshlrev_b32 v19, 16, v19
    v_lshlrev_b32 v20, 16, v20
    v_lshlrev_b32 v21, 16, v21
    v_mul_f32 v11, v13, v11
    v_mul_f32 v12, v15, v12
    v_pk_mul_f32 v[18:19], v[18:19], v[14:15] op_sel_hi:[1,0]
    v_exp_f32 v30, v11
    v_fract_f32 v31, v12
    v_mul_f32 v32, 0x43800000, v11
    v_mul_f32 v33, 0x43800000, v12
    v_exp_f32 v32, v32
    v_fract_f32 v33, v33
    v_cos_f32 v22, v31
    v_sin_f32 v23, v31
    v_cos_f32 v24, v33
    v_sin_f32_e64 v25, v33
    v_pk_mul_f32 v[22:23], v[22:23], v[30:31] op_sel_hi:[1,0]
    v_pk_mul_f32 v[24:25], v[24:25], v[32:33] op_sel_hi:[1,0]
    v_pk_mul_f32 v[30:31], v[20:21], v[18:19] op_sel_hi:[0,1]
    v_pk_mul_f32 v[32:33], v[22:23], v[22:23] op_sel_hi:[0,1]
    v_pk_fma_f32 v[34:35], v[20:21], v[18:19], v[30:31] op_sel:[1,1,0] op_sel_hi:[1,0,1] neg_lo:[0,1,0]
    v_pk_fma_f32 v[26:27], v[22:23], v[22:23], v[32:33] op_sel:[1,1,0] op_sel_hi:[1,0,1] neg_lo:[0,1,0]
    v_pk_mul_f32 v[30:31], v[34:35], v[22:23] op_sel_hi:[0,1]
    v_pk_mul_f32 v[32:33], v[34:35], v[24:25] op_sel_hi:[0,1]
    v_pk_mul_f32 v[44:45], v[34:35], v[26:27] op_sel_hi:[0,1]
    v_pk_mul_f32 v[46:47], v[26:27], v[26:27] op_sel_hi:[0,1]
    v_pk_fma_f32 v[38:39], v[34:35], v[22:23], v[30:31] op_sel:[1,1,0] op_sel_hi:[1,0,1] neg_lo:[0,1,0]
    v_pk_fma_f32 v[40:41], v[34:35], v[24:25], v[32:33] op_sel:[1,1,0] op_sel_hi:[1,0,1] neg_lo:[0,1,0]
    v_pk_fma_f32 v[36:37], v[34:35], v[26:27], v[44:45] op_sel:[1,1,0] op_sel_hi:[1,0,1] neg_lo:[0,1,0]
    v_pk_fma_f32 v[28:29], v[26:27], v[26:27], v[46:47] op_sel:[1,1,0] op_sel_hi:[1,0,1] neg_lo:[0,1,0]
    v_cvt_pk_bf16_f32 v60, v34, -v35
    ds_write_addtid_b32 v60 offset:0
    v_cvt_pk_bf16_f32 v61, v38, -v39
    ds_write_addtid_b32 v61 offset:544
    v_cvt_pk_bf16_f32 v62, v40, -v41
    ds_write_addtid_b32 v62 offset:4352
    v_cvt_pk_bf16_f32 v63, v36, -v37
    ds_write_addtid_b32 v63 offset:1088
    v_pk_mul_f32 v[30:31], v[40:41], v[26:27] op_sel_hi:[0,1]
    v_pk_mul_f32 v[32:33], v[40:41], v[28:29] op_sel_hi:[0,1]
    v_pk_mul_f32 v[44:45], v[40:41], v[24:25] op_sel_hi:[0,1]
    v_pk_mul_f32 v[46:47], v[38:39], v[26:27] op_sel_hi:[0,1]
    v_pk_mul_f32 v[50:51], v[36:37], v[26:27] op_sel_hi:[0,1]
    v_pk_fma_f32 v[42:43], v[40:41], v[26:27], v[30:31] op_sel:[1,1,0] op_sel_hi:[1,0,1] neg_lo:[0,1,0]
    v_pk_fma_f32 v[48:49], v[40:41], v[28:29], v[32:33] op_sel:[1,1,0] op_sel_hi:[1,0,1] neg_lo:[0,1,0]
    v_pk_fma_f32 v[40:41], v[40:41], v[24:25], v[44:45] op_sel:[1,1,0] op_sel_hi:[1,0,1] neg_lo:[0,1,0]
    v_pk_fma_f32 v[38:39], v[38:39], v[26:27], v[46:47] op_sel:[1,1,0] op_sel_hi:[1,0,1] neg_lo:[0,1,0]
    v_pk_fma_f32 v[36:37], v[36:37], v[26:27], v[50:51] op_sel:[1,1,0] op_sel_hi:[1,0,1] neg_lo:[0,1,0]
    v_cvt_pk_bf16_f32 v60, v42, -v43
    ds_write_addtid_b32 v60 offset:4896
    v_cvt_pk_bf16_f32 v61, v48, -v49
    ds_write_addtid_b32 v61 offset:5440
    v_cvt_pk_bf16_f32 v62, v40, -v41
    ds_write_addtid_b32 v62 offset:6528
    v_cvt_pk_bf16_f32 v63, v38, -v39
    ds_write_addtid_b32 v63 offset:1632
    v_cvt_pk_bf16_f32 v60, v36, -v37
    ds_write_addtid_b32 v60 offset:2176
    v_pk_mul_f32 v[30:31], v[48:49], v[26:27] op_sel_hi:[0,1]
    v_pk_mul_f32 v[32:33], v[40:41], v[28:29] op_sel_hi:[0,1]
    v_pk_mul_f32 v[44:45], v[40:41], v[24:25] op_sel_hi:[0,1]
    v_pk_mul_f32 v[46:47], v[38:39], v[26:27] op_sel_hi:[0,1]
    v_pk_mul_f32 v[50:51], v[36:37], v[26:27] op_sel_hi:[0,1]
    v_pk_fma_f32 v[42:43], v[48:49], v[26:27], v[30:31] op_sel:[1,1,0] op_sel_hi:[1,0,1] neg_lo:[0,1,0]
    v_pk_fma_f32 v[48:49], v[40:41], v[28:29], v[32:33] op_sel:[1,1,0] op_sel_hi:[1,0,1] neg_lo:[0,1,0]
    v_pk_fma_f32 v[40:41], v[40:41], v[24:25], v[44:45] op_sel:[1,1,0] op_sel_hi:[1,0,1] neg_lo:[0,1,0]
    v_pk_fma_f32 v[38:39], v[38:39], v[26:27], v[46:47] op_sel:[1,1,0] op_sel_hi:[1,0,1] neg_lo:[0,1,0]
    v_pk_fma_f32 v[36:37], v[36:37], v[26:27], v[50:51] op_sel:[1,1,0] op_sel_hi:[1,0,1] neg_lo:[0,1,0]
    v_cvt_pk_bf16_f32 v61, v42, -v43
    ds_write_addtid_b32 v61 offset:5984
    v_cvt_pk_bf16_f32 v62, v48, -v49
    ds_write_addtid_b32 v62 offset:7072
    v_cvt_pk_bf16_f32 v63, v40, -v41
    ds_write_addtid_b32 v63 offset:7616
    v_cvt_pk_bf16_f32 v60, v38, -v39
    ds_write_addtid_b32 v60 offset:2720
    v_cvt_pk_bf16_f32 v61, v36, -v37
    ds_write_addtid_b32 v61 offset:3264
    v_pk_mul_f32 v[32:33], v[40:41], v[28:29] op_sel_hi:[0,1]
    v_pk_mul_f32 v[44:45], v[40:41], v[24:25] op_sel_hi:[0,1]
    v_pk_mul_f32 v[46:47], v[38:39], v[26:27] op_sel_hi:[0,1]
    v_pk_mul_f32 v[50:51], v[24:25], v[24:25] op_sel_hi:[0,1]
    v_pk_fma_f32 v[48:49], v[40:41], v[28:29], v[32:33] op_sel:[1,1,0] op_sel_hi:[1,0,1] neg_lo:[0,1,0]
    v_pk_fma_f32 v[40:41], v[40:41], v[24:25], v[44:45] op_sel:[1,1,0] op_sel_hi:[1,0,1] neg_lo:[0,1,0]
    v_pk_fma_f32 v[38:39], v[38:39], v[26:27], v[46:47] op_sel:[1,1,0] op_sel_hi:[1,0,1] neg_lo:[0,1,0]
    v_pk_fma_f32 v[52:53], v[24:25], v[24:25], v[50:51] op_sel:[1,1,0] op_sel_hi:[1,0,1] neg_lo:[0,1,0]
    v_cvt_pk_bf16_f32 v62, v48, -v49
    ds_write_addtid_b32 v62 offset:8160
    v_cvt_pk_bf16_f32 v63, v40, -v41
    ds_write_addtid_b32 v63 offset:8704
    v_cvt_pk_bf16_f32 v60, v38, -v39
    ds_write_addtid_b32 v60 offset:3808
    v_pk_mul_f32 v[30:31], v[40:41], v[24:25] op_sel_hi:[0,1]
    v_pk_mul_f32 v[32:33], v[40:41], v[52:53] op_sel_hi:[0,1]
    v_pk_fma_f32 v[42:43], v[40:41], v[24:25], v[30:31] op_sel:[1,1,0] op_sel_hi:[1,0,1] neg_lo:[0,1,0]
    v_pk_fma_f32 v[48:49], v[40:41], v[52:53], v[32:33] op_sel:[1,1,0] op_sel_hi:[1,0,1] neg_lo:[0,1,0]
    v_cvt_pk_bf16_f32 v61, v42, -v43
    ds_write_addtid_b32 v61 offset:9248
    v_cvt_pk_bf16_f32 v62, v48, -v49
    ds_write_addtid_b32 v62 offset:9792
    v_pk_mul_f32 v[30:31], v[42:43], v[52:53] op_sel_hi:[0,1]
    v_pk_mul_f32 v[32:33], v[48:49], v[52:53] op_sel_hi:[0,1]
    v_pk_fma_f32 v[42:43], v[42:43], v[52:53], v[30:31] op_sel:[1,1,0] op_sel_hi:[1,0,1] neg_lo:[0,1,0]
    v_pk_fma_f32 v[48:49], v[48:49], v[52:53], v[32:33] op_sel:[1,1,0] op_sel_hi:[1,0,1] neg_lo:[0,1,0]
    v_cvt_pk_bf16_f32 v63, v42, -v43
    ds_write_addtid_b32 v63 offset:10336
    v_cvt_pk_bf16_f32 v60, v48, -v49
    ds_write_addtid_b32 v60 offset:10880
    s_waitcnt vmcnt(0) lgkmcnt(0)
    s_barrier
    s_waitcnt lgkmcnt(0)
    s_barrier
    ds_read_b128 v[16:19], v126 offset:16
    ds_read_b64 v[20:21], v126 offset:8
    ds_read_b32 v22, v126 offset:32
    ds_write_b32 v113, v104
    s_waitcnt lgkmcnt(3)
    v_cndmask_b32 v17, v17, v16, s[56:57]
    v_cndmask_b32 v18, v18, v16, s[62:63]
    v_perm_b32 v24, v16, v16, v122
    v_perm_b32 v25, v18, v17, v123
    s_waitcnt lgkmcnt(1)
    v_perm_b32 v26, v22, v18, v124
    v_perm_b32 v27, v22, v19, v125
    v_perm_b32 v28, v16, v21, v121
    v_perm_b32 v23, v16, v20, v120
    ds_write_b128 v127, v[24:27]
    v_mov_b32 v29, v24
    v_mov_b32 v30, v25
    v_mov_b32_e64 v31, v26
    ds_write_b128 v127, v[28:31] offset:8320
    v_alignbit_b32 v32, v24, v28, 16
    v_alignbit_b32 v33, v25, v24, 16
    v_alignbit_b32 v34, v26, v25, 16
    v_alignbit_b32 v35, v27, v26, 16
    ds_write_b128 v127, v[32:35] offset:4160
    v_alignbit_b32 v36, v28, v23, 16
    v_mov_b32 v37, v32
    v_mov_b32 v38, v33
    v_mov_b32 v39, v34
    ds_write_b128 v127, v[36:39] offset:12480
    s_lshl_b32 s53, s58, 13
    s_add_u32 s53, s53, 9437184
    v_lshlrev_b32 v126, 4, v0
    s_waitcnt lgkmcnt(0)
    s_cmp_eq_u32 s58, 0
    s_cselect_b32 s4, 8, 5
    s_cmp_ge_u32 s3, s4
    s_cbranch_scc1 L_END
    s_barrier
    s_barrier
    s_cmp_lg_u32 s3, 4
    s_cbranch_scc1 A_S2
    v_mov_b32 v40, -1
    v_mov_b32 v41, -1
    v_mov_b32 v42, -1
    v_mov_b32 v43, -1
    s_add_u32 s55, s53, 4096
    buffer_store_dwordx4 v[40:43], v2, s[12:15], s53 offen offset:0 sc1
    buffer_store_dwordx4 v[40:43], v2, s[12:15], s53 offen offset:1024 sc1
    buffer_store_dwordx4 v[40:43], v2, s[12:15], s53 offen offset:2048 sc1
    buffer_store_dwordx4 v[40:43], v2, s[12:15], s53 offen offset:3072 sc1
    buffer_store_dwordx4 v[40:43], v2, s[12:15], s55 offen offset:0 sc1
    buffer_store_dwordx4 v[40:43], v2, s[12:15], s55 offen offset:1024 sc1
    buffer_store_dwordx4 v[40:43], v2, s[12:15], s55 offen offset:2048 sc1
    buffer_store_dwordx4 v[40:43], v2, s[12:15], s55 offen offset:3072 sc1
    s_waitcnt vmcnt(0)
    s_mov_b64 exec, 255
    v_mul_u32_u24 v60, 1280, v1
    v_mov_b32 v61, s96
    s_add_u32 s5, s97, 2326528
    buffer_store_dword v61, v60, s[12:15], s5 offen sc0 sc1
    s_mov_b64 exec, -1
    s_cmp_lg_u32 s58, 0
    s_cbranch_scc1 L_END
A_S2:
    global_load_dwordx4 v[112:115], v2, s[20:21] offset:-3072
    global_load_dwordx4 v[116:119], v2, s[20:21] offset:-2048
    global_load_dwordx4 v[120:123], v2, s[20:21] offset:-1024
    global_load_dwordx4 v[124:127], v2, s[20:21] offset:0
    s_sub_u32 s7, s3, 4
    v_lshl_add_u32 v7, v4, 6, v10
    s_lshl_b32 s4, s7, 3
    v_lshl_add_u32 v110, v7, 5, s4
    s_lshl_b32 s4, s7, 2
    v_lshl_add_u32 v109, v7, 4, s4
    s_mov_b32 s23, 2097152
    s_mov_b32 s25, 2162688
    s_mov_b32 s28, 2166784
    s_mov_b32 s63, 2195456
    s_mov_b32 s7, 1
    s_and_b32 s5, s2, 7
    s_mul_i32 s5, s5, 1280
    s_mov_b32 s6, 65536
    s_add_u32 s98, s5, 2293760
LPOLL8:
    buffer_load_dwordx4 v[60:63], v2, s[12:15], s98 offen sc1
    s_waitcnt vmcnt(0)
    v_xor_b32 v60, s96, v60
    v_xor_b32 v61, s96, v61
    v_xor_b32 v62, s96, v62
    v_xor_b32 v63, s96, v63
    v_or3_b32 v60, v60, v61, v62
    v_or_b32 v60, v60, v63
    v_cmp_ne_u32 vcc, 0, v60
    s_sub_u32 s6, s6, 1
    s_cbranch_scc1 LPOLX8
    s_cbranch_vccz LPOLX8
    s_sleep 4
    s_branch LPOLL8
LPOLX8:
    buffer_load_dwordx2 v[72:73], v110, s[12:15], s23 offen offset:0 sc1
    buffer_load_dwordx2 v[76:77], v110, s[12:15], s23 offen offset:512 sc1
    buffer_load_dwordx2 v[74:75], v110, s[12:15], s23 offen offset:1024 sc1
    buffer_load_dwordx2 v[78:79], v110, s[12:15], s23 offen offset:1536 sc1
    buffer_load_dword v80, v109, s[12:15], s25 offen offset:0 sc1
    buffer_load_dword v84, v109, s[12:15], s28 offen offset:0 sc1
    buffer_load_dword v81, v109, s[12:15], s25 offen offset:256 sc1
    buffer_load_dword v85, v109, s[12:15], s28 offen offset:256 sc1
    buffer_load_dword v82, v109, s[12:15], s25 offen offset:512 sc1
    buffer_load_dword v86, v109, s[12:15], s28 offen offset:512 sc1
    buffer_load_dword v83, v109, s[12:15], s25 offen offset:768 sc1
    buffer_load_dword v87, v109, s[12:15], s28 offen offset:768 sc1
    s_waitcnt vmcnt(0)
    s_branch B_FFT
A_NYS:
    buffer_store_dwordx2 v[48:49], v110, s[12:15], s63 offen offset:0 sc1
    buffer_store_dwordx2 v[50:51], v110, s[12:15], s63 offen offset:512 sc1
    buffer_store_dwordx2 v[52:53], v110, s[12:15], s63 offen offset:1024 sc1
    buffer_store_dwordx2 v[54:55], v110, s[12:15], s63 offen offset:1536 sc1
    s_branch L_END
B_PF:
    s_cmp_ge_u32 s3, 6
    s_cbranch_scc1 L_EXIT
    s_and_b32 s60, s2, 7
    s_lshr_b32 s61, s2, 3
    s_mov_b32 s4, 2359296
    s_cmp_eq_u32 s3, 5
    s_cbranch_scc1 B_H
    s_mov_b32 s10, 2097152
    s_mov_b32 s11, 0x20000
    s_lshr_b32 s53, s61, 2
    s_lshl_b32 s53, s53, 3
    s_add_u32 s30, s60, s53
    s_and_b32 s31, s61, 3
    v_lshlrev_b32 v6, 4, v10
    v_lshlrev_b32 v5, 5, v4
    v_xor_b32 v6, v5, v6
    v_lshl_add_u32 v6, v4, 10, v6
    v_xor_b32 v5, 128, v6
    s_lshl_b32 s54, s30, 15
    s_lshl_b32 s56, s31, 8
    s_add_u32 s55, s54, s56
    s_mov_b32 m0, 16448
    s_waitcnt lgkmcnt(0)
    buffer_load_dwordx4 v6, s[8:11], s55 offen lds
    s_add_u32 m0, m0, 1024
    s_add_u32 s55, s55, 4096
    buffer_load_dwordx4 v6, s[8:11], s55 offen lds
    s_add_u32 m0, m0, 1024
    s_add_u32 s55, s55, 4096
    buffer_load_dwordx4 v5, s[8:11], s55 offen lds
    s_add_u32 m0, m0, 1024
    s_add_u32 s55, s55, 4096
    buffer_load_dwordx4 v5, s[8:11], s55 offen lds
    s_add_u32 m0, m0, 1024
    s_add_u32 s55, s55, 4096
    buffer_load_dwordx4 v6, s[8:11], s55 offen lds
    s_add_u32 m0, m0, 1024
    s_add_u32 s55, s55, 4096
    buffer_load_dwordx4 v6, s[8:11], s55 offen lds
    s_add_u32 m0, m0, 1024
    s_add_u32 s55, s55, 4096
    buffer_load_dwordx4 v5, s[8:11], s55 offen lds
    s_add_u32 m0, m0, 1024
    s_add_u32 s55, s55, 4096
    buffer_load_dwordx4 v5, s[8:11], s55 offen lds
    s_load_dword s96, s[12:13], s4
    v_bfe_u32 v7, v1, 2, 2
    v_and_b32 v8, 1, v4
    v_lshl_or_b32 v8, v8, 2, v7
    v_lshl_add_u32 v7, v4, 3, v7
    v_lshlrev_b32 v7, 8, v7
    v_lshl_add_u32 v7, v8, 5, v7
    v_and_b32 v8, 3, v1
    v_lshl_add_u32 v48, v8, 3, v7
    v_xor_b32 v49, 32, v48
    v_xor_b32 v50, 64, v48
    v_xor_b32 v51, 96, v48
    v_xor_b32 v52, 128, v48
    v_xor_b32 v53, 160, v48
    v_xor_b32 v54, 192, v48
    v_xor_b32 v55, 224, v48
    v_lshlrev_b32_e64 v5, 6, v10
    v_lshl_add_u32 v5, v4, 4, v5
    s_lshl_b32 s55, s31, 13
    s_add_u32 s54, s54, s55
    s_add_u32 s54, s54, 3145728
    s_add_u32 s55, s54, 4096
    s_waitcnt vmcnt(0) lgkmcnt(0)
    ds_read_b64_tr_b16 v[16:17], v48 offset:16448
    ds_read_b64_tr_b16 v[18:19], v48 offset:17472
    ds_read_b64_tr_b16 v[20:21], v49 offset:16448
    ds_read_b64_tr_b16 v[22:23], v49 offset:17472
    ds_read_b64_tr_b16 v[24:25], v50 offset:16448
    ds_read_b64_tr_b16 v[26:27], v50 offset:17472
    ds_read_b64_tr_b16 v[28:29], v51 offset:16448
    ds_read_b64_tr_b16 v[30:31], v51 offset:17472
    ds_read_b64_tr_b16 v[32:33], v52 offset:16448
    ds_read_b64_tr_b16 v[34:35], v52 offset:17472
    ds_read_b64_tr_b16 v[36:37], v53 offset:16448
    ds_read_b64_tr_b16 v[38:39], v53 offset:17472
    ds_read_b64_tr_b16 v[40:41], v54 offset:16448
    ds_read_b64_tr_b16 v[42:43], v54 offset:17472
    s_waitcnt lgkmcnt(12)
    ds_read_b64_tr_b16 v[44:45], v55 offset:16448
    ds_read_b64_tr_b16 v[46:47], v55 offset:17472
    s_waitcnt lgkmcnt(14)
    buffer_store_dwordx4 v[16:19], v5, s[12:15], s54 offen offset:0 sc1
    s_waitcnt lgkmcnt(12)
    buffer_store_dwordx4 v[20:23], v5, s[12:15], s54 offen offset:1024 sc1
    s_waitcnt lgkmcnt(10)
    buffer_store_dwordx4 v[24:27], v5, s[12:15], s54 offen offset:2048 sc1
    s_waitcnt lgkmcnt(8)
    buffer_store_dwordx4 v[28:31], v5, s[12:15], s54 offen offset:3072 sc1
    s_waitcnt lgkmcnt(6)
    buffer_store_dwordx4 v[32:35], v5, s[12:15], s55 offen offset:0 sc1
    s_waitcnt lgkmcnt(4)
    buffer_store_dwordx4 v[36:39], v5, s[12:15], s55 offen offset:1024 sc1
    s_waitcnt lgkmcnt(2)
    buffer_store_dwordx4 v[40:43], v5, s[12:15], s55 offen offset:2048 sc1
    s_waitcnt lgkmcnt(0)
    buffer_store_dwordx4 v[44:47], v5, s[12:15], s55 offen offset:3072 sc1
    s_add_u32 s96, s96, 1
    s_barrier
    s_waitcnt vmcnt(0)
    s_mov_b64 exec, 255
    v_mul_u32_u24 v60, 1280, v1
    v_mov_b32 v61, s96
    s_add_u32 s5, s97, 2342912
    buffer_store_dword v61, v60, s[12:15], s5 offen sc0 sc1
    s_mov_b64 exec, -1
    s_branch L_END
B_H:
    s_getpc_b64 s[20:21]
    s_add_u32 s20, s20, L_CODE@rel32@lo+4100
    s_addc_u32 s21, s21, L_CODE@rel32@hi+4108
    s_getpc_b64 s[24:25]
    s_add_u32 s24, s24, P1_TAB@rel32@lo+4100
    s_addc_u32 s25, s25, P1_TAB@rel32@hi+4108
    s_lshl_b32 s26, s61, 10
    v_add_u32 v3, s26, v2
    v_min_u32 v5, L_CEND-L_CODE-16, v3
    global_load_dwordx4 v[20:23], v5, s[20:21] offset:-4096
    v_min_u32 v5, TAB_END-P1_TAB-16, v3
    global_load_dwordx4 v[24:27], v5, s[24:25] offset:-4096
    s_waitcnt lgkmcnt(0)
    s_load_dword s96, s[12:13], s4
    s_mov_b32 s32, s48
    s_mov_b32 s33, s49
    s_mov_b32 s36, s50
    s_mov_b32 s37, s51
    s_mov_b32 s34, 1052672
    s_mov_b32 s35, 0x20000
    s_mov_b32 s38, 1052672
    s_mov_b32 s39, 0x20000
    s_lshl_b32 s26, s61, 6
    s_add_u32 s26, s26, s60
    s_mul_i32 s26, s26, 514
    v_lshrrev_b32 v5, 3, v1
    v_mul_u32_u24 v5, 4112, v5
    v_and_b32 v6, 7, v1
    v_mul_u32_u24 v6, 73, v6
    v_add_u32 v5, v5, v6
    v_mov_b32 v40, -1
    v_mov_b32 v41, -1
    v_mov_b32 v42, -1
    v_mov_b32 v43, -1
    s_lshl_b32 s63, s60, 5
    s_add_u32 s63, s63, s61
    s_lshl_b32 s63, s63, 13
    s_add_u32 s62, s63, 6291456
    s_add_u32 s63, s62, 4096
    s_waitcnt vmcnt(0) lgkmcnt(0)
    s_add_u32 s96, s96, 1
    s_barrier
    s_barrier
    s_barrier
    s_barrier
    buffer_store_dwordx4 v[40:43], v2, s[12:15], s62 offen offset:0 sc1
    buffer_store_dwordx4 v[40:43], v2, s[12:15], s62 offen offset:1024 sc1
    buffer_store_dwordx4 v[40:43], v2, s[12:15], s62 offen offset:2048 sc1
    buffer_store_dwordx4 v[40:43], v2, s[12:15], s62 offen offset:3072 sc1
    buffer_store_dwordx4 v[40:43], v2, s[12:15], s63 offen offset:0 sc1
    buffer_store_dwordx4 v[40:43], v2, s[12:15], s63 offen offset:1024 sc1
    buffer_store_dwordx4 v[40:43], v2, s[12:15], s63 offen offset:2048 sc1
    buffer_store_dwordx4 v[40:43], v2, s[12:15], s63 offen offset:3072 sc1
    s_waitcnt vmcnt(0)
    s_mov_b64 exec, 255
    v_mul_u32_u24 v60, 1280, v1
    v_mov_b32 v61, s96
    s_add_u32 s5, s97, 2310144
    buffer_store_dword v61, v60, s[12:15], s5 offen sc0 sc1
    s_mov_b64 exec, -1
    s_branch L_END
L_EXIT:
    s_endpgm
L_CEND:
.section .rodata,"a"
.p2align 6
.amdhsa_kernel gated_mix__ssm_conv_s4__spectral_gfnet__prompt_kernel
  .amdhsa_next_free_vgpr 128
  .amdhsa_next_free_sgpr 102
  .amdhsa_accum_offset 128
  .amdhsa_group_segment_fixed_size 0
  .amdhsa_kernarg_size 128
  .amdhsa_user_sgpr_count 2
  .amdhsa_user_sgpr_kernarg_segment_ptr 1
  .amdhsa_system_sgpr_workgroup_id_x 1
.end_amdhsa_kernel
.p2align 7
P1_TAB:
.long 0x3f803f80,0x3f803f80,0x3f803f80,0x3f803f80,0x3f7b3f80,0x3f553f6d,0xbf7bbf80,0xbf55bf6d
.long 0x3f6d3f80,0x3ec43f35,0x3f6d3f80,0x3ec43f35,0x3f553f80,0xbe483ec4,0xbf55bf80,0x3e48bec4
.long 0x3f353f80,0xbf35248d,0x3f353f80,0xbf35261f,0x3f0e3f80,0xbf7bbec4,0xbf0ebf80,0x3f7b3ec4
.long 0x3ec43f80,0xbf6dbf35,0x3ec43f80,0xbf6dbf35,0x3e483f80,0xbf0ebf6d,0xbe48bf80,0x3f0e3f6d
.long 0x248d3f80,0xa554bf80,0xa6543f80,0xa754bf80,0xbe483f80,0x3f0ebf6d,0x3e48bf80,0xbf0e3f6d
.long 0xbec43f80,0x3f6dbf35,0xbec43f80,0x3f6dbf35,0xbf0e3f80,0x3f7bbec4,0x3f0ebf80,0xbf7b3ec4
.long 0xbf353f80,0x3f35a554,0xbf353f80,0x3f35a777,0xbf553f80,0x3e483ec4,0x3f55bf80,0xbe48bec4
.long 0xbf6d3f80,0xbec43f35,0xbf6d3f80,0xbec43f35,0xbf7b3f80,0xbf553f6d,0x3f7bbf80,0x3f55bf6d
.long 0x3f803f80,0x3f803f80,0x3f803f80,0x3f803f80,0x3f0e3f35,0x3e483ec4,0xbf0ebf35,0xbe48bec4
.long 0xbec4248d,0xbf6dbf35,0xbec425b0,0xbf6dbf35,0xbf7bbf35,0xbf0ebf6d,0x3f7b3f35,0x3f0e3f6d
.long 0xbf35bf80,0x3f35a554,0xbf35bf80,0x3f35a731,0x3e48bf35,0x3f553f6d,0xbe483f35,0xbf55bf6d
.long 0x3f6da554,0xbec43f35,0x3f6da742,0xbec43f35,0x3f553f35,0xbf7bbec4,0xbf55bf35,0x3f7b3ec4
.long 0x25b03f80,0xa5f7bf80,0xa60d3f80,0xa765bf80,0xbf553f35,0x3f7bbec4,0x3f55bf35,0xbf7b3ec4
.long 0xbf6d25b0,0x3ec43f35,0xbf6da58e,0x3ec43f35,0xbe48bf35,0xbf553f6d,0x3e483f35,0x3f55bf6d
.long 0x3f35bf80,0xbf35261f,0x3f35bf80,0xbf352804,0x3f7bbf35,0x3f0ebf6d,0xbf7b3f35,0xbf0e3f6d
.long 0x3ec4a5f7,0x3f6dbf35,0x3ec4a78d,0x3f6dbf35,0xbf0e3f35,0xbe483ec4,0x3f0ebf35,0x3e48bec4
.long 0x3f803f80,0x3f803f80,0x3f803f80,0x3f803f80,0xbe48248d,0xbf0ebec4,0x3e48a554,0x3f0e3ec4
.long 0xbf6dbf80,0xbec4bf35,0xbf6dbf80,0xbec4bf35,0x3f0ea554,0x3f7b3f6d,0xbf0e261f,0xbf7bbf6d
.long 0x3f353f80,0xbf3525b0,0x3f353f80,0xbf35a68d,0xbf5525b0,0xbe48bf6d,0x3f55a742,0x3e483f6d
.long 0xbec4bf80,0x3f6d3f35,0xbec4bf80,0x3f6d3f35,0x3f7ba5f7,0xbf553ec4,0xbf7ba60d,0x3f55bec4
.long 0x261f3f80,0xa731bf80,0xa58e3f80,0xa777bf80,0xbf7b261f,0x3f553ec4,0x3f7ba777,0xbf55bec4
.long 0x3ec4bf80,0xbf6d3f35,0x3ec4bf80,0xbf6d3f35,0x3f55a731,0x3e48bf6d,0xbf55258d,0xbe483f6d
.long 0xbf353f80,0x3f35a742,0xbf353f80,0x3f352754,0xbf0ea68d,0xbf7b3f6d,0x3f0ea796,0x3f7bbf6d
.long 0x3f6dbf80,0x3ec4bf35,0x3f6dbf80,0x3ec4bf35,0x3e48a742,0x3f0ebec4,0xbe48268d,0xbf0e3ec4
.long 0x3f803f80,0x3f803f80,0x3f803f80,0x3f803f80,0xbf55bf35,0xbf7bbf6d,0x3f553f35,0x3f7b3f6d
.long 0x3ec4a554,0x3f6d3f35,0x3ec4a5f7,0x3f6d3f35,0x3e483f35,0xbf55bec4,0xbe48bf35,0x3f553ec4
.long 0xbf35bf80,0x3f35a5f7,0xbf35bf80,0x3f35a742,0x3f7b3f35,0xbf0e3ec4,0xbf7bbf35,0x3f0ebec4
.long 0xbf6d261f,0x3ec4bf35,0xbf6da60d,0x3ec4bf35,0x3f0ebf35,0xbe483f6d,0xbf0e3f35,0x3e48bf6d
.long 0xa68d3f80,0xa742bf80,0xa1373f80,0xa784bf80,0xbf0ebf35,0x3e483f6d,0x3f0e3f35,0xbe48bf6d
.long 0x3f6da742,0xbec4bf35,0x3f6da78d,0xbec4bf35,0xbf7b3f35,0x3f0e3ec4,0x3f7bbf35,0xbf0ebec4
.long 0x3f35bf80,0xbf35a60d,0x3f35bf80,0xbf352889,0xbe483f35,0x3f55bec4,0x3e48bf35,0xbf553ec4
.long 0xbec4a60d,0xbf6d3f35,0xbec42816,0xbf6d3f35,0x3f55bf35,0x3f7bbf6d,0xbf553f35,0xbf7b3f6d
.long 0xbf803f80,0xbf803f80,0xbf803f80,0xbf803f80,0xbe488000,0xbf0ebec4,0x3e48a50d,0x3f0e3ec4
.long 0xbec48000,0xbf6dbf35,0xbec4258d,0xbf6dbf35,0xbf0e8000,0xbf7bbf6d,0x3f0ea5d4,0x3f7b3f6d
.long 0xbf358000,0xbf35bf80,0xbf35260d,0xbf35bf80,0xbf558000,0xbe48bf6d,0x3f55a630,0x3e483f6d
.long 0xbf6d8000,0x3ec4bf35,0xbf6d2654,0x3ec4bf35,0xbf7b8000,0x3f55bec4,0x3f7ba677,0xbf553ec4
.long 0xbf808000,0x3f80a50d,0xbf80268d,0x3f80a69f,0xbf7b8000,0x3f553ec4,0x3f7ba69f,0xbf55bec4
.long 0xbf6d8000,0x3ec43f35,0xbf6d26b0,0x3ec43f35,0xbf558000,0xbe483f6d,0x3f55a7b1,0x3e48bf6d
.long 0xbf358000,0xbf353f80,0xbf3526d4,0xbf353f80,0xbf0e8000,0xbf7b3f6d,0x3f0e270d,0x3f7bbf6d
.long 0xbec48000,0xbf6d3f35,0xbec426f7,0xbf6d3f35,0xbe488000,0xbf0e3ec4,0x3e48a7c2,0x3f0ebec4
.long 0xbf803f80,0xbf803f80,0xbf803f80,0xbf803f80,0xbf55bf35,0xbf7bbf6d,0x3f553f35,0x3f7b3f6d
.long 0xbf6dbf80,0xbec4bf35,0xbf6dbf80,0xbec4bf35,0xbe48bf35,0x3f553ec4,0x3e483f35,0xbf55bec4
.long 0x3f35a50d,0x3f353f80,0x3f35a630,0x3f353f80,0x3f7b3f35,0xbf0e3ec4,0xbf7bbf35,0x3f0ebec4
.long 0x3ec43f80,0xbf6dbf35,0x3ec43f80,0xbf6dbf35,0xbf0e3f35,0x3e48bf6d,0x3f0ebf35,0xbe483f6d
.long 0xbf80258d,0x3f80a5d4,0xbf8026b0,0x3f80a7b1,0xbf0ebf35,0x3e483f6d,0x3f0e3f35,0xbe48bf6d
.long 0x3ec4bf80,0xbf6d3f35,0x3ec4bf80,0xbf6d3f35,0x3f7bbf35,0xbf0ebec4,0xbf7b3f35,0x3f0e3ec4
.long 0x3f35a5d4,0x3f35bf80,0x3f35a7c2,0x3f35bf80,0xbe483f35,0x3f55bec4,0x3e48bf35,0xbf553ec4
.long 0xbf6d3f80,0xbec43f35,0xbf6d3f80,0xbec43f35,0xbf553f35,0xbf7b3f6d,0x3f55bf35,0x3f7bbf6d
.long 0xbf803f80,0xbf803f80,0xbf803f80,0xbf803f80,0xbf7bbf80,0xbf55bf6d,0x3f7b3f80,0x3f553f6d
.long 0x3ec4a50d,0x3f6d3f35,0x3ec4a5d4,0x3f6d3f35,0x3f553f80,0xbe483ec4,0xbf55bf80,0x3e48bec4
.long 0xbf35258d,0xbf35bf80,0xbf352654,0xbf35bf80,0xbf0ebf80,0x3f7b3ec4,0x3f0e3f80,0xbf7bbec4
.long 0x3f6da5d4,0xbec43f35,0x3f6da69f,0xbec43f35,0x3e483f80,0xbf0ebf6d,0xbe48bf80,0x3f0e3f6d
.long 0xbf80260d,0x3f80a630,0xbf8026d4,0x3f80270d,0x3e48bf80,0xbf0e3f6d,0xbe483f80,0x3f0ebf6d
.long 0x3f6da630,0xbec4bf35,0x3f6da7c2,0xbec4bf35,0xbf0e3f80,0x3f7bbec4,0x3f0ebf80,0xbf7b3ec4
.long 0xbf352654,0xbf353f80,0xbf35271f,0xbf353f80,0x3f55bf80,0xbe48bec4,0xbf553f80,0x3e483ec4
.long 0x3ec4a677,0x3f6dbf35,0x3ec4268d,0x3f6dbf35,0xbf7b3f80,0xbf553f6d,0x3f7bbf80,0x3f55bf6d
.long 0xbf803f80,0xbf803f80,0xbf803f80,0xbf803f80,0xbf0ebf35,0xbe48bec4,0x3f0e3f35,0x3e483ec4
.long 0x3f6d3f80,0x3ec43f35,0x3f6d3f80,0x3ec43f35,0xbf7bbf35,0xbf0ebf6d,0x3f7b3f35,0x3f0e3f6d
.long 0x3f35a5d4,0x3f353f80,0x3f35a677,0x3f353f80,0xbe483f35,0xbf55bf6d,0x3e48bf35,0x3f553f6d
.long 0xbec4bf80,0x3f6d3f35,0xbec4bf80,0x3f6d3f35,0x3f553f35,0xbf7bbec4,0xbf55bf35,0x3f7b3ec4
.long 0xbf802654,0x3f80a677,0xbf8026f7,0x3f80a7c2,0x3f55bf35,0xbf7b3ec4,0xbf553f35,0x3f7bbec4
.long 0xbec43f80,0x3f6dbf35,0xbec43f80,0x3f6dbf35,0xbe48bf35,0xbf553f6d,0x3e483f35,0x3f55bf6d
.long 0x3f35a69f,0x3f35bf80,0x3f35268d,0x3f35bf80,0xbf7b3f35,0xbf0e3f6d,0x3f7bbf35,0x3f0ebf6d
.long 0x3f6dbf80,0x3ec4bf35,0x3f6dbf80,0x3ec4bf35,0xbf0e3f35,0xbe483ec4,0x3f0ebf35,0x3e48bec4
.long 0x3f800000,0x3f800000,0x3f800000,0x3f800000,0x3f800000,0x3f7ffb11,0x3f7fec43,0x3f7fd397
.long 0x3f800000,0x3f7fec43,0x3f7fb10f,0x3f7f4e6d,0x3f800000,0x3f7fd397,0x3f7f4e6d,0x3f7e70b0
.long 0x3f800000,0x3f7fb10f,0x3f7ec46d,0x3f7d3aac,0x3f800000,0x3f7f84ab,0x3f7e1324,0x3f7baccd
.long 0x3f800000,0x3f7f4e6d,0x3f7d3aac,0x3f79c79d,0x3f800000,0x3f7f0e58,0x3f7c3b28,0x3f778bc5
.long 0x3f800000,0x3f7ec46d,0x3f7b14be,0x3f74fa0b,0x3f800000,0x3f7e70b0,0x3f79c79d,0x3f721352
.long 0x3f800000,0x3f7e1324,0x3f7853f8,0x3f6ed89e,0x3f800000,0x3f7dabcc,0x3f76ba07,0x3f6b4b0c
.long 0x3f800000,0x3f7d3aac,0x3f74fa0b,0x3f676bd8,0x3f800000,0x3f7cbfc9,0x3f731447,0x3f633c5a
.long 0x3f800000,0x3f7c3b28,0x3f710908,0x3f5ebe05,0x3f800000,0x3f7baccd,0x3f6ed89e,0x3f59f26a
.long 0x3f800000,0x3f800000,0x3f800000,0x3f800000,0x3f7fb10f,0x3f7f84ab,0x3f7f4e6d,0x3f7f0e58
.long 0x3f7ec46d,0x3f7e1324,0x3f7d3aac,0x3f7c3b28,0x3f7d3aac,0x3f7baccd,0x3f79c79d,0x3f778bc5
.long 0x3f7b14be,0x3f7853f8,0x3f74fa0b,0x3f710908,0x3f7853f8,0x3f740bdd,0x3f6ed89e,0x3f68bf3c
.long 0x3f74fa0b,0x3f6ed89e,0x3f676bd8,0x3f5ebe05,0x3f710908,0x3f68bf3c,0x3f5ebe05,0x3f531849
.long 0x3f6c835e,0x3f61c598,0x3f54db31,0x3f45e403,0x3f676bd8,0x3f59f26a,0x3f49d112,0x3f373a23
.long 0x3f61c598,0x3f514d3d,0x3f3daef9,0x3f273656,0x3f5b941a,0x3f47de65,0x3f3085bb,0x3f15f6d9
.long 0x3f54db31,0x3f3daef9,0x3f226799,0x3f039c3d,0x3f4d9f02,0x3f32c8c9,0x3f13682a,0x3ee0924f
.long 0x3f45e403,0x3f273656,0x3f039c3d,0x3eb8442a,0x3f3daef9,0x3f1b02c6,0x3ee63375,0x3e8e9a22
.long 0x3f800000,0x3f800000,0x3f800000,0x3f800000,0x3f7ec46d,0x3f7e70b0,0x3f7e1324,0x3f7dabcc
.long 0x3f7b14be,0x3f79c79d,0x3f7853f8,0x3f76ba07,0x3f74fa0b,0x3f721352,0x3f6ed89e,0x3f6b4b0c
.long 0x3f6c835e,0x3f676bd8,0x3f61c598,0x3f5b941a,0x3f61c598,0x3f59f26a,0x3f514d3d,0x3f47de65
.long 0x3f54db31,0x3f49d112,0x3f3daef9,0x3f3085bb,0x3f45e403,0x3f373a23,0x3f273656,0x3f15f6d9
.long 0x3f3504f3,0x3f226799,0x3f0e39da,0x3ef15aea,0x3f226799,0x3f0b9a6b,0x3ee63375,0x3eb263ef
.long 0x3f0e39da,0x3ee63375,0x3eac7cd4,0x3e605c13,0x3ef15aea,0x3eb263ef,0x3e605c13,0x3dafb680
.long 0x3ec3ef15,0x3e78cfcc,0x3dc8bd36,0xbd48fb30,0x3e94a031,0x3e09cf86,0xbcc90ab0,0xbe3b6ecf
.long 0x3e47c5c2,0x3cc90ab0,0xbe164083,0xbea09ae5,0x3dc8bd36,0xbdafb680,0xbe888e93,0xbee0924f
.long 0x3f800000,0x3f800000,0x3f800000,0x3f800000,0x3f7d3aac,0x3f7cbfc9,0x3f7c3b28,0x3f7baccd
.long 0x3f74fa0b,0x3f731447,0x3f710908,0x3f6ed89e,0x3f676bd8,0x3f633c5a,0x3f5ebe05,0x3f59f26a
.long 0x3f54db31,0x3f4d9f02,0x3f45e403,0x3f3daef9,0x3f3daef9,0x3f32c8c9,0x3f273656,0x3f1b02c6
.long 0x3f226799,0x3f13682a,0x3f039c3d,0x3ee63375,0x3f039c3d,0x3ee0924f,0x3eb8442a,0x3e8e9a22
.long 0x3ec3ef15,0x3e94a031,0x3e47c5c2,0x3dc8bd36,0x3e78cfcc,0x3e09cf86,0x3cc90ab0,0xbdafb680
.long 0x3dc8bd36,0xbcc90ab0,0xbe164083,0xbe888e93,0xbd48fb30,0xbe3b6ecf,0xbea09ae5,0xbee0924f
.long 0xbe47c5c2,0xbeac7cd4,0xbef15aea,0xbf187fc0,0xbeac7cd4,0xbef6e0cb,0xbf1d7fd1,0xbf3b8f3b
.long 0xbef15aea,0xbf1d7fd1,0xbf3daef9,0xbf584853,0xbf187fc0,0xbf3b8f3b,0xbf584853,0xbf6db293
.long 0x0,0x0,0x0,0x0,0x0,0x3c490e90,0x3cc90ab0,0x3d16c32c
.long 0x0,0x3cc90ab0,0x3d48fb30,0x3d96a905,0x0,0x3d16c32c,0x3d96a905,0x3de1bc2e
.long 0x0,0x3d48fb30,0x3dc8bd36,0x3e164083,0x0,0x3d7b2b74,0x3dfab273,0x3e3b6ecf
.long 0x0,0x3d96a905,0x3e164083,0x3e605c13,0x0,0x3dafb680,0x3e2f10a2,0x3e827dc0
.long 0x0,0x3dc8bd36,0x3e47c5c2,0x3e94a031,0x0,0x3de1bc2e,0x3e605c13,0x3ea68f12
.long 0x0,0x3dfab273,0x3e78cfcc,0x3eb8442a,0x0,0x3e09cf86,0x3e888e93,0x3ec9b953
.long 0x0,0x3e164083,0x3e94a031,0x3edae880,0x0,0x3e22abb6,0x3ea09ae5,0x3eebcbbb
.long 0x0,0x3e2f10a2,0x3eac7cd4,0x3efc5d27,0x0,0x3e3b6ecf,0x3eb8442a,0x3f064b82
.long 0x0,0x0,0x0,0x0,0x3d48fb30,0x3d7b2b74,0x3d96a905,0x3dafb680
.long 0x3dc8bd36,0x3dfab273,0x3e164083,0x3e2f10a2,0x3e164083,0x3e3b6ecf,0x3e605c13,0x3e827dc0
.long 0x3e47c5c2,0x3e78cfcc,0x3e94a031,0x3eac7cd4,0x3e78cfcc,0x3e9aa086,0x3eb8442a,0x3ed53641
.long 0x3e94a031,0x3eb8442a,0x3edae880,0x3efc5d27,0x3eac7cd4,0x3ed53641,0x3efc5d27,0x3f10d3cd
.long 0x3ec3ef15,0x3ef15aea,0x3f0e39da,0x3f226799,0x3edae880,0x3f064b82,0x3f1d7fd1,0x3f32c8c9
.long 0x3ef15aea,0x3f13682a,0x3f2beb4a,0x3f41d870,0x3f039c3d,0x3f1ff6cb,0x3f396842,0x3f4f7a1f
.long 0x3f0e39da,0x3f2beb4a,0x3f45e403,0x3f5b941a,0x3f187fc0,0x3f373a23,0x3f514d3d,0x3f660f88
.long 0x3f226799,0x3f41d870,0x3f5b941a,0x3f6ed89e,0x3f2beb4a,0x3f4bbbf8,0x3f64aa59,0x3f75dec6
.long 0x0,0x0,0x0,0x0,0x3dc8bd36,0x3de1bc2e,0x3dfab273,0x3e09cf86
.long 0x3e47c5c2,0x3e605c13,0x3e78cfcc,0x3e888e93,0x3e94a031,0x3ea68f12,0x3eb8442a,0x3ec9b953
.long 0x3ec3ef15,0x3edae880,0x3ef15aea,0x3f039c3d,0x3ef15aea,0x3f064b82,0x3f13682a,0x3f1ff6cb
.long 0x3f0e39da,0x3f1d7fd1,0x3f2beb4a,0x3f396842,0x3f226799,0x3f32c8c9,0x3f41d870,0x3f4f7a1f
.long 0x3f3504f3,0x3f45e403,0x3f54db31,0x3f61c598,0x3f45e403,0x3f5695e5,0x3f64aa59,0x3f6ff573
.long 0x3f54db31,0x3f64aa59,0x3f710908,0x3f79c79d,0x3f61c598,0x3f6ff573,0x3f79c79d,0x3f7f0e58
.long 0x3f6c835e,0x3f7853f8,0x3f7ec46d,0x3f7fb10f,0x3f74fa0b,0x3f7dabcc,0x3f7fec43,0x3f7baccd
.long 0x3f7b14be,0x3f7fec43,0x3f7d3aac,0x3f731447,0x3f7ec46d,0x3f7f0e58,0x3f76ba07,0x3f660f88
.long 0x0,0x0,0x0,0x0,0x3e164083,0x3e22abb6,0x3e2f10a2,0x3e3b6ecf
.long 0x3e94a031,0x3ea09ae5,0x3eac7cd4,0x3eb8442a,0x3edae880,0x3eebcbbb,0x3efc5d27,0x3f064b82
.long 0x3f0e39da,0x3f187fc0,0x3f226799,0x3f2beb4a,0x3f2beb4a,0x3f373a23,0x3f41d870,0x3f4bbbf8
.long 0x3f45e403,0x3f514d3d,0x3f5b941a,0x3f64aa59,0x3f5b941a,0x3f660f88,0x3f6ed89e,0x3f75dec6
.long 0x3f6c835e,0x3f74fa0b,0x3f7b14be,0x3f7ec46d,0x3f7853f8,0x3f7dabcc,0x3f7fec43,0x3f7f0e58
.long 0x3f7ec46d,0x3f7fec43,0x3f7d3aac,0x3f76ba07,0x3f7fb10f,0x3f7baccd,0x3f731447,0x3f660f88
.long 0x3f7b14be,0x3f710908,0x3f61c598,0x3f4d9f02,0x3f710908,0x3f604621,0x3f49d112,0x3f2e3bde
.long 0x3f61c598,0x3f49d112,0x3f2beb4a,0x3f08f59b,0x3f4d9f02,0x3f2e3bde,0x3f08f59b,0x3ebe1d4a
.long 0x3f80,0x3f80,0x3f80,0x3f80,0x3f80,0x3ec43f6d,0x3f353f35,0x3f6d3ec4
.long 0x3f80,0x3f353f35,0x3f80248d,0x3f35bf35,0x3f80,0x3f6d3ec4,0x3f35bf35,0xbec4bf6d
.long 0x3f80,0xbec43f6d,0xbf353f35,0xbf6d3ec4,0x3f80,0xbf353f35,0xbf80a5f7,0xbf35bf35
.long 0x3f80,0xbf6d3ec4,0xbf35bf35,0x3ec4bf6d,0x3f80,0xbf80a554,0x25d4bf80,0x3f80261f
.long 0x3f80,0x3f80248d,0x250dbf80,0xbf80a554,0x3f80,0x3f6dbec4,0xbf35bf35,0xbec43f6d
.long 0x3f80,0x3f35bf35,0xbf80a554,0x3f353f35,0x3f80,0x3ec4bf6d,0xbf353f35,0x3f6dbec4
.long 0x3f80,0xbf6dbec4,0x3f35bf35,0x3ec43f6d,0x3f80,0xbf35bf35,0x3f8025b0,0xbf353f35
.long 0x3f80,0xbec4bf6d,0x3f353f35,0xbf6dbec4,0x3f80,0x250dbf80,0xa58d3f80,0x25d4bf80
.long 0x3f80,0x3f80,0x3f80,0x3f80,0x3f80248d,0x3f6dbec4,0x3f35bf35,0x3ec4bf6d
.long 0x250dbf80,0xbf35bf35,0xbf80a554,0xbf353f35,0xbf80a554,0xbec43f6d,0x3f353f35,0x3f6dbec4
.long 0xbf80a742,0xbf6dbec4,0xbf35bf35,0xbec4bf6d,0x2677bf80,0x3f35bf35,0x3f80a60d,0x3f353f35
.long 0x3f80a68d,0x3ec43f6d,0xbf353f35,0xbf6dbec4,0xa6543f80,0xbf80a742,0x269fbf80,0x3f80a60d
.long 0xa58d3f80,0x3f8025b0,0x25d4bf80,0xbf80a5f7,0x3f8025b0,0xbec4bf6d,0xbf353f35,0x3f6d3ec4
.long 0x25d4bf80,0xbf353f35,0x3f80261f,0xbf35bf35,0xbf80a5f7,0x3f6d3ec4,0xbf35bf35,0x3ec43f6d
.long 0xbf80a731,0x3ec4bf6d,0x3f353f35,0xbf6d3ec4,0x2630bf80,0x3f353f35,0xbf80a742,0x3f35bf35
.long 0x3f80261f,0xbf6d3ec4,0x3f35bf35,0xbec43f6d,0xa60d3f80,0x2630bf80,0xa6543f80,0x2677bf80
.long 0x3f80,0x3f80,0x3f80,0x3f80,0x250dbf80,0xbec4bf6d,0xbf35bf35,0xbf6dbec4
.long 0xa58d3f80,0x3f353f35,0x3f8025b0,0x3f35bf35,0x25d4bf80,0xbf6dbec4,0xbf353f35,0x3ec43f6d
.long 0x27c2bf80,0x3ec4bf6d,0x3f35bf35,0x3f6dbec4,0xa6f73f80,0xbf353f35,0xbf80a78d,0xbf35bf35
.long 0xa70dbf80,0x3f6dbec4,0x3f353f35,0xbec43f6d,0xa6d43f80,0xbf80a777,0x27c2bf80,0x3f802804
.long 0xa60d3f80,0x3f80261f,0x2630bf80,0xbf80a731,0x2630bf80,0xbf6d3ec4,0x3f353f35,0x3ec4bf6d
.long 0xa6543f80,0x3f35bf35,0xbf80a742,0x3f353f35,0x2677bf80,0xbec43f6d,0x3f35bf35,0xbf6d3ec4
.long 0x27b1bf80,0x3f6d3ec4,0xbf353f35,0xbec4bf6d,0xa6b03f80,0xbf35bf35,0x3f80a58e,0xbf353f35
.long 0x269fbf80,0x3ec43f6d,0xbf35bf35,0x3f6d3ec4,0xa68d3f80,0x269fbf80,0xa6b03f80,0x27b1bf80
.long 0x3f80,0x3f80,0x3f80,0x3f80,0xbf80a554,0xbf6d3ec4,0xbf353f35,0xbec43f6d
.long 0x25d4bf80,0xbf35bf35,0xbf80a5f7,0xbf353f35,0x3f80261f,0x3ec4bf6d,0xbf35bf35,0xbf6d3ec4
.long 0x3f80268d,0x3f6d3ec4,0x3f353f35,0x3ec43f6d,0xa68dbf80,0x3f35bf35,0x3f802816,0x3f353f35
.long 0xbf80a796,0xbec4bf6d,0x3f35bf35,0x3f6d3ec4,0xa71f3f80,0xbf802754,0xa68dbf80,0x3f802889
.long 0xa6543f80,0x3f80a68d,0x2677bf80,0xbf80a742,0xbf80a742,0x3ec43f6d,0x3f35bf35,0xbf6dbec4
.long 0x269fbf80,0xbf353f35,0x3f80a60d,0xbf35bf35,0x3f80a60d,0xbf6dbec4,0x3f353f35,0xbec4bf6d
.long 0x3f80258d,0xbec43f6d,0xbf35bf35,0x3f6dbec4,0x27c2bf80,0x3f353f35,0xbf80a78d,0x3f35bf35
.long 0xbf80a777,0x3f6dbec4,0xbf353f35,0x3ec4bf6d,0xa6d43f80,0xa70dbf80,0xa6f73f80,0x27c2bf80
.long 0x3f808000,0x3f808000,0x3f808000,0x3f808000,0x3f808000,0x3f6dbec4,0x3f35bf35,0x3ec4bf6d
.long 0x3f808000,0x3f35bf35,0x248dbf80,0xbf35bf35,0x3f808000,0x3ec4bf6d,0xbf35bf35,0xbf6d3ec4
.long 0xbf800000,0xbf6dbec4,0xbf35bf35,0xbec4bf6d,0xbf800000,0xbf35bf35,0x25f7bf80,0x3f35bf35
.long 0xbf800000,0xbec4bf6d,0x3f35bf35,0x3f6d3ec4,0xbf800000,0x2554bf80,0x3f8025d4,0xa61f3f80
.long 0x3f808000,0x248dbf80,0xbf80a50d,0xa5543f80,0x3f808000,0xbec4bf6d,0xbf353f35,0x3f6d3ec4
.long 0x3f808000,0xbf35bf35,0xa5543f80,0x3f35bf35,0x3f808000,0xbf6dbec4,0x3f353f35,0xbec4bf6d
.long 0xbf800000,0x3ec4bf6d,0x3f353f35,0xbf6d3ec4,0xbf800000,0x3f35bf35,0xa5b03f80,0xbf35bf35
.long 0xbf800000,0x3f6dbec4,0xbf353f35,0x3ec4bf6d,0xbf800000,0x3f80250d,0xbf80a58d,0x3f8025d4
.long 0x3f808000,0x3f808000,0x3f808000,0x3f808000,0x248dbf80,0xbec4bf6d,0xbf35bf35,0xbf6dbec4
.long 0xbf80a50d,0xbf353f35,0xa5543f80,0x3f353f35,0xa5543f80,0x3f6d3ec4,0x3f35bf35,0xbec4bf6d
.long 0x2742bf80,0x3ec4bf6d,0x3f35bf35,0x3f6dbec4,0x3f802677,0x3f353f35,0x260d3f80,0xbf353f35
.long 0x268d3f80,0xbf6d3ec4,0xbf35bf35,0x3ec4bf6d,0xbf80a654,0x2742bf80,0x3f80269f,0x260d3f80
.long 0x3f80258d,0x25b0bf80,0xbf80a5d4,0xa5f73f80,0x25b0bf80,0xbf6d3ec4,0x3f353f35,0x3ec4bf6d
.long 0xbf80a5d4,0x3f353f35,0x261fbf80,0xbf353f35,0xa5f73f80,0x3ec4bf6d,0xbf353f35,0x3f6dbec4
.long 0x2731bf80,0x3f6d3ec4,0xbf353f35,0xbec4bf6d,0x3f802630,0xbf353f35,0x2742bf80,0x3f353f35
.long 0xa61f3f80,0xbec4bf6d,0x3f353f35,0xbf6dbec4,0xbf80a60d,0x3f802630,0xbf80a654,0x3f802677
.long 0x3f808000,0x3f808000,0x3f808000,0x3f808000,0xbf80a50d,0xbf6d3ec4,0xbf353f35,0xbec43f6d
.long 0x3f80258d,0x3f35bf35,0x25b0bf80,0xbf35bf35,0xbf80a5d4,0xbec43f6d,0x3f353f35,0x3f6dbec4
.long 0x3f8027c2,0x3f6d3ec4,0x3f353f35,0x3ec43f6d,0xbf80a6f7,0xbf35bf35,0x278dbf80,0x3f35bf35
.long 0x3f80a70d,0x3ec43f6d,0xbf353f35,0xbf6dbec4,0xbf80a6d4,0x2777bf80,0x3f8027c2,0xa8043f80
.long 0x3f80260d,0x261fbf80,0xbf80a630,0xa7313f80,0xbf80a630,0x3ec43f6d,0x3f35bf35,0xbf6dbec4
.long 0x3f802654,0xbf35bf35,0xa7423f80,0x3f35bf35,0xbf80a677,0x3f6d3ec4,0xbf35bf35,0x3ec43f6d
.long 0x3f8027b1,0xbec43f6d,0xbf35bf35,0x3f6dbec4,0xbf80a6b0,0x3f35bf35,0x258e3f80,0xbf35bf35
.long 0x3f80269f,0xbf6d3ec4,0x3f35bf35,0xbec43f6d,0xbf80a68d,0x3f80269f,0xbf80a6b0,0x3f8027b1
.long 0x3f808000,0x3f808000,0x3f808000,0x3f808000,0xa5543f80,0x3ec43f6d,0x3f353f35,0x3f6d3ec4
.long 0xbf80a5d4,0xbf353f35,0xa5f73f80,0x3f353f35,0x261fbf80,0xbf6dbec4,0xbf353f35,0x3ec43f6d
.long 0xa68d3f80,0xbec43f6d,0xbf353f35,0xbf6d3ec4,0x3f80a68d,0x3f353f35,0xa8163f80,0xbf353f35
.long 0x2796bf80,0x3f6dbec4,0x3f353f35,0xbec43f6d,0xbf80a71f,0xa754bf80,0x3f80a68d,0xa8893f80
.long 0x3f802654,0xa68dbf80,0xbf80a677,0xa7423f80,0xa7423f80,0x3f6dbec4,0xbf35bf35,0xbec43f6d
.long 0xbf80a69f,0x3f353f35,0xa60dbf80,0xbf353f35,0xa60dbf80,0xbec43f6d,0x3f35bf35,0xbf6d3ec4
.long 0xa58d3f80,0xbf6dbec4,0x3f35bf35,0x3ec43f6d,0x3f8027c2,0xbf353f35,0x278dbf80,0x3f353f35
.long 0x2777bf80,0x3ec43f6d,0xbf35bf35,0x3f6d3ec4,0xbf80a6d4,0x3f80a70d,0xbf80a6f7,0x3f8027c2
.long 0x0,0x0,0x0,0x0,0x0,0xbec4baf9,0xbf35389e,0xbf6db907
.long 0x0,0xbf35389e,0xbf801fc5,0xbf35b89e,0x0,0xbf6db907,0xbf35b89e,0x3ec43af9
.long 0x3f80bf80,0x3fafbf6d,0x3fd1bf35,0x3fe1bec4,0x3f80bf80,0x3fc5bf35,0x3fb125f7,0x3f033f35
.long 0x3f80bf80,0x3fbebec4,0x3ea63f35,0xbfaf3f6d,0x3f80bf80,0x3f992554,0xbf6d3f80,0xbfc7a61f
.long 0x0,0xbf801fc5,0xa50d0000,0x3f802059,0x0,0xbf6d3907,0x3f35b89e,0x3ec4baf9
.long 0x0,0xbf35b89e,0x3f802059,0xbf35389e,0x0,0xbec43af9,0x3f35389e,0xbf6d3907
.long 0x3f80bf80,0x3f3b3ec4,0xbfd13f35,0x3e31bf6d,0x3f80bf80,0x3e1b3f35,0xbfb1a5b0,0x3fd8bf35
.long 0x3f80bf80,0xbee63f6d,0xbea6bf35,0x3f8f3ec4,0x3f80bf80,0xbf7b3f80,0x3f6dbf80,0xbf553f80
.long 0x0,0x0,0x0,0x0,0xbf801fc5,0xbf6d3907,0xbf35b89e,0xbec43af9
.long 0xa50d0000,0x3f35b89e,0x3f802059,0x3f35389e,0x3f802059,0x3ec4baf9,0xbf35389e,0xbf6d3907
.long 0x3fdb2742,0x3fbe3ec4,0x3f8b3f35,0x3f143f6d,0xbf353f80,0xbfd83f35,0xbff6260d,0xbfa2bf35
.long 0xbfdb268d,0xbe40bf6d,0x3fd1bf35,0x3fe13ec4,0x3f35bf80,0x3fea2742,0xbec43f80,0xbffe260d
.long 0x258d0000,0xbf80217b,0xa5d40000,0x3f80a031,0xbf80217b,0x3ec43af9,0x3f35389e,0xbf6db907
.long 0xa5d40000,0x3f35389e,0xbf80a123,0x3f35b89e,0x3f80a031,0xbf6db907,0x3f35b89e,0xbec4baf9
.long 0x3fdb2731,0xbf9b3f6d,0xbf8bbf35,0x3ff4bec4,0xbf353f80,0xbf67bf35,0x3ff62742,0xbfc53f35
.long 0xbfdba61f,0x3ff4bec4,0xbfd13f35,0x3f70bf6d,0x3f35bf80,0xbf0e3f80,0x3ec4bf80,0xbe483f80
.long 0x0,0x0,0x0,0x0,0xa50d0000,0x3ec43af9,0x3f35b89e,0x3f6d3907
.long 0x258d0000,0xbf35389e,0xbf80217b,0xbf35b89e,0xa5d40000,0x3f6d3907,0x3f35389e,0xbec4baf9
.long 0xa7c03f80,0xbf143f6d,0xbf8b3f35,0xbfbe3ec4,0x26ddbf80,0x3fa2bf35,0x3ff6278d,0x3fd83f35
.long 0x27233f80,0xbfe13ec4,0xbfd1bf35,0x3e40bf6d,0x2696bf80,0x3ffe2777,0x3ec43f80,0xbfeaa804
.long 0x260d0000,0xbf80a123,0xa6300000,0x3f8022ee,0xa6300000,0x3f6db907,0xbf35389e,0xbec43af9
.long 0x26540000,0xbf35b89e,0x3f80a23c,0xbf35389e,0xa6770000,0x3ec4baf9,0xbf35b89e,0x3f6db907
.long 0xa79d3f80,0xbff4bec4,0x3f8bbf35,0x3f9b3f6d,0xa6b1bf80,0x3fc53f35,0xbff6258e,0x3f67bf35
.long 0xa7163f80,0xbf70bf6d,0x3fd13f35,0xbff4bec4,0xa6f7bf80,0x3e483f80,0xbec4bf80,0x3f0e3f80
.long 0x0,0x0,0x0,0x0,0x3f802059,0x3f6db907,0x3f35389e,0x3ec4baf9
.long 0xa5d40000,0x3f35b89e,0x3f80a031,0x3f35389e,0xbf80a123,0xbec43af9,0x3f35b89e,0x3f6db907
.long 0xbfdba68d,0xbfe1bec4,0xbfd1bf35,0xbfafbf6d,0x3f353f80,0xbf033f35,0xbfb1a816,0xbfc5bf35
.long 0x3fdb2796,0x3faf3f6d,0xbea63f35,0xbfbebec4,0xbf35bf80,0x3fc7a754,0x3f6d3f80,0xbf99a889
.long 0x26540000,0xbf80a210,0xa6770000,0x3f80a23c,0x3f80a23c,0xbec4baf9,0xbf35b89e,0x3f6d3907
.long 0xa69f0000,0x3f35389e,0xbf80a1be,0x3f35b89e,0xbf80a1be,0x3f6d3907,0xbf35389e,0x3ec43af9
.long 0xbfdba58d,0xbe31bf6d,0x3fd13f35,0xbf3b3ec4,0x3f353f80,0xbfd8bf35,0x3fb1278d,0xbe1b3f35
.long 0x3fdb2777,0xbf8f3ec4,0x3ea6bf35,0x3ee63f6d,0xbf35bf80,0x3f553f80,0xbf6dbf80,0x3f7b3f80
.long 0xbf803f80,0xbf80bf80,0xbf803f80,0xbf80bf80,0xbf800000,0xbf6d3907,0xbf35b89e,0xbec43af9
.long 0xbf800000,0xbf35b89e,0xa48d0000,0x3f35b89e,0xbf800000,0xbec43af9,0x3f35b89e,0x3f6db907
.long 0x3f800000,0x3f3b3ec4,0x3ea63f35,0xbe313f6d,0x3f800000,0x3e1b3f35,0xbf6d3f80,0xbfd83f35
.long 0x3f800000,0xbee63f6d,0xbfd13f35,0xbf8fbec4,0x3f800000,0xbf7b3f80,0xbfb1a5d4,0x3f55bf80
.long 0xbf800000,0xa48d0000,0x3f80a045,0x25540000,0xbf800000,0x3ec43af9,0x3f35389e,0xbf6db907
.long 0xbf800000,0x3f35b89e,0x25540000,0xbf35b89e,0xbf800000,0x3f6d3907,0xbf35389e,0x3ec43af9
.long 0x3f800000,0xbfaf3f6d,0xbea6bf35,0x3fe1bec4,0x3f800000,0xbfc53f35,0x3f6dbf80,0x3f033f35
.long 0x3f800000,0xbfbe3ec4,0x3fd1bf35,0xbfaf3f6d,0x3f800000,0xbf99a50d,0x3fb1258d,0xbfc7a5d4
.long 0xbf803f80,0xbf80bf80,0xbf803f80,0xbf80bf80,0xa48d0000,0x3ec43af9,0x3f35b89e,0x3f6d3907
.long 0x3f80a045,0x3f35389e,0x25540000,0xbf35389e,0x25540000,0xbf6db907,0xbf35b89e,0x3ec43af9
.long 0xbf353f80,0xbf9b3f6d,0xbfd13f35,0xbff43ec4,0xbfdba677,0xbf67bf35,0x3ec4bf80,0x3fc5bf35
.long 0x3f35bf80,0x3ff4bec4,0x3f8b3f35,0xbf703f6d,0x3fdb2654,0xbf0e3f80,0xbff6a69f,0x3e48bf80
.long 0xbf8020c5,0xa5b00000,0x3f8020d9,0x25f70000,0xa5b00000,0x3f6db907,0xbf35389e,0xbec43af9
.long 0x3f8020d9,0xbf35389e,0xa61f0000,0x3f35389e,0x25f70000,0xbec43af9,0x3f35389e,0xbf6d3907
.long 0xbf353f80,0xbfbebec4,0x3fd1bf35,0x3f143f6d,0xbfdba630,0x3fd8bf35,0xbec43f80,0xbfa2bf35
.long 0x3f35bf80,0x3e403f6d,0xbf8bbf35,0x3fe13ec4,0x3fdb260d,0xbfeaa630,0x3ff62654,0xbffea677
.long 0xbf803f80,0xbf80bf80,0xbf803f80,0xbf80bf80,0x3f80a045,0x3f6db907,0x3f35389e,0x3ec4baf9
.long 0xbf8020c5,0xbf35b89e,0xa5b00000,0x3f35b89e,0x3f8020d9,0x3ec4baf9,0xbf35389e,0xbf6d3907
.long 0xc000a7c2,0xbff4bec4,0xbfd1bf35,0xbf9bbf6d,0x400026f7,0x3fc53f35,0x3ec43f80,0xbf673f35
.long 0xc000270d,0xbf70bf6d,0x3f8bbf35,0x3ff43ec4,0x400026d4,0x3e483f80,0xbff6a7c2,0xbf0ebf80
.long 0xbf802145,0xa61f0000,0x3f80a1fb,0x27310000,0x3f80a1fb,0xbec4baf9,0xbf35b89e,0x3f6d3907
.long 0xbf80a159,0x3f35b89e,0x27420000,0xbf35b89e,0x3f80a0b1,0xbf6db907,0x3f35b89e,0xbec4baf9
.long 0xc000a7b1,0x3f14bf6d,0x3fd13f35,0xbfbe3ec4,0x400026b0,0xbfa23f35,0xbec4bf80,0x3fd83f35
.long 0xc000a69f,0x3fe1bec4,0xbf8b3f35,0x3e40bf6d,0x4000268d,0xbffea69f,0x3ff626b0,0xbfeaa7b1
.long 0xbf803f80,0xbf80bf80,0xbf803f80,0xbf80bf80,0x25540000,0xbec4baf9,0xbf35389e,0xbf6db907
.long 0x3f8020d9,0x3f35389e,0x25f70000,0xbf35389e,0xa61f0000,0x3f6d3907,0x3f35389e,0xbec4baf9
.long 0xbf35bf80,0xbe31bf6d,0x3ea6bf35,0x3f3bbec4,0xbfdb268d,0xbfd8bf35,0xbf6dbf80,0x3e1bbf35
.long 0x3f353f80,0xbf8f3ec4,0xbfd1bf35,0xbee6bf6d,0x3fdb271f,0x3f553f80,0xbfb1268d,0xbf7bbf80
.long 0xbf80a159,0x268d0000,0x3f80a0b1,0x27420000,0x27420000,0xbf6d3907,0x3f35b89e,0x3ec4baf9
.long 0x3f8021a3,0xbf35389e,0x260d0000,0x3f35389e,0x260d0000,0x3ec4baf9,0xbf35b89e,0x3f6db907
.long 0xbf35bf80,0x3fe13ec4,0xbea63f35,0xbfafbf6d,0xbfdba7c2,0x3f03bf35,0x3f6d3f80,0xbfc5bf35
.long 0x3f353f80,0xbfafbf6d,0x3fd13f35,0xbfbebec4,0x3fdb26d4,0xbfc7270d,0x3fb126f7,0xbf99a7c2
.p2align 7
P2_TAB:
.long 0x0,0x800,0x0,0x0,0x2,0xa00,0x0,0x0
.long 0x4,0xc00,0x0,0x0,0x6,0xe00,0x0,0x0
.long 0x8,0x1000,0x0,0x0,0xa,0x1002,0x0,0x0
.long 0xc,0x1002,0x0,0x0,0xe,0x1002,0x0,0x0
.long 0x200,0x1002,0x0,0x0,0x204,0x1002,0x0,0x0
.long 0x208,0x1002,0x0,0x0,0x20c,0x1002,0x0,0x0
.long 0x400,0x1002,0x0,0x0,0x408,0x1002,0x0,0x0
.long 0x600,0x1002,0x0,0x0,0x608,0x1002,0x0,0x0
.long 0x0,0x800,0x0,0x0,0x2,0xa00,0x0,0x0
.long 0x4,0xc00,0x0,0x0,0x6,0xe00,0x0,0x0
.long 0x8,0x1000,0x0,0x0,0xa,0x1002,0x0,0x0
.long 0xc,0x1002,0x0,0x0,0xe,0x1002,0x0,0x0
.long 0x200,0x1002,0x0,0x0,0x204,0x1002,0x0,0x0
.long 0x208,0x1002,0x0,0x0,0x20c,0x1002,0x0,0x0
.long 0x400,0x1002,0x0,0x0,0x408,0x1002,0x0,0x0
.long 0x600,0x1002,0x0,0x0,0x608,0x1002,0x0,0x0
.long 0x0,0x800,0x0,0x0,0x2,0xa00,0x0,0x0
.long 0x4,0xc00,0x0,0x0,0x6,0xe00,0x0,0x0
.long 0x8,0x1000,0x0,0x0,0xa,0x1002,0x0,0x0
.long 0xc,0x1002,0x0,0x0,0xe,0x1002,0x0,0x0
.long 0x200,0x1002,0x0,0x0,0x204,0x1002,0x0,0x0
.long 0x208,0x1002,0x0,0x0,0x20c,0x1002,0x0,0x0
.long 0x400,0x1002,0x0,0x0,0x408,0x1002,0x0,0x0
.long 0x600,0x1002,0x0,0x0,0x608,0x1002,0x0,0x0
.long 0x0,0x800,0x0,0x0,0x2,0xa00,0x0,0x0
.long 0x4,0xc00,0x0,0x0,0x6,0xe00,0x0,0x0
.long 0x8,0x1000,0x0,0x0,0xa,0x1002,0x0,0x0
.long 0xc,0x1002,0x0,0x0,0xe,0x1002,0x0,0x0
.long 0x200,0x1002,0x0,0x0,0x204,0x1002,0x0,0x0
.long 0x208,0x1002,0x0,0x0,0x20c,0x1002,0x0,0x0
.long 0x400,0x1002,0x0,0x0,0x408,0x1002,0x0,0x0
.long 0x600,0x1002,0x0,0x0,0x608,0x1002,0x0,0x0
.long 0x3f80,0x3f80,0x3f80,0x3f80,0x3f80,0x3ec43f6d,0x3f353f35,0x3f6d3ec4
.long 0x3f80,0x3f353f35,0x3f80248d,0x3f35bf35,0x3f80,0x3f6d3ec4,0x3f35bf35,0xbec4bf6d
.long 0x3f80,0x3f80248d,0x250dbf80,0xbf80a554,0x3f80,0x3f6dbec4,0xbf35bf35,0xbec43f6d
.long 0x3f80,0x3f35bf35,0xbf80a554,0x3f353f35,0x3f80,0x3ec4bf6d,0xbf353f35,0x3f6dbec4
.long 0x3f80,0x250dbf80,0xa58d3f80,0x25d4bf80,0x3f80,0xbec4bf6d,0x3f353f35,0xbf6dbec4
.long 0x3f80,0xbf35bf35,0x3f8025b0,0xbf353f35,0x3f80,0xbf6dbec4,0x3f35bf35,0x3ec43f6d
.long 0x3f80,0xbf80a554,0x25d4bf80,0x3f80261f,0x3f80,0xbf6d3ec4,0xbf35bf35,0x3ec4bf6d
.long 0x3f80,0xbf353f35,0xbf80a5f7,0xbf35bf35,0x3f80,0xbec43f6d,0xbf353f35,0xbf6d3ec4
.long 0x3f80,0x3f80,0x3f80,0x3f80,0x3f80248d,0x3f6dbec4,0x3f35bf35,0x3ec4bf6d
.long 0x250dbf80,0xbf35bf35,0xbf80a554,0xbf353f35,0xbf80a554,0xbec43f6d,0x3f353f35,0x3f6dbec4
.long 0xa58d3f80,0x3f8025b0,0x25d4bf80,0xbf80a5f7,0x3f8025b0,0xbec4bf6d,0xbf353f35,0x3f6d3ec4
.long 0x25d4bf80,0xbf353f35,0x3f80261f,0xbf35bf35,0xbf80a5f7,0x3f6d3ec4,0xbf35bf35,0x3ec43f6d
.long 0xa60d3f80,0x2630bf80,0xa6543f80,0x2677bf80,0x3f80261f,0xbf6d3ec4,0x3f35bf35,0xbec43f6d
.long 0x2630bf80,0x3f353f35,0xbf80a742,0x3f35bf35,0xbf80a731,0x3ec4bf6d,0x3f353f35,0xbf6d3ec4
.long 0xa6543f80,0xbf80a742,0x269fbf80,0x3f80a60d,0x3f80a68d,0x3ec43f6d,0xbf353f35,0xbf6dbec4
.long 0x2677bf80,0x3f35bf35,0x3f80a60d,0x3f353f35,0xbf80a742,0xbf6dbec4,0xbf35bf35,0xbec4bf6d
.long 0x3f80,0x3f80,0x3f80,0x3f80,0x250dbf80,0xbec4bf6d,0xbf35bf35,0xbf6dbec4
.long 0xa58d3f80,0x3f353f35,0x3f8025b0,0x3f35bf35,0x25d4bf80,0xbf6dbec4,0xbf353f35,0x3ec43f6d
.long 0xa60d3f80,0x3f80261f,0x2630bf80,0xbf80a731,0x2630bf80,0xbf6d3ec4,0x3f353f35,0x3ec4bf6d
.long 0xa6543f80,0x3f35bf35,0xbf80a742,0x3f353f35,0x2677bf80,0xbec43f6d,0x3f35bf35,0xbf6d3ec4
.long 0xa68d3f80,0x269fbf80,0xa6b03f80,0x27b1bf80,0x269fbf80,0x3ec43f6d,0xbf35bf35,0x3f6d3ec4
.long 0xa6b03f80,0xbf35bf35,0x3f80a58e,0xbf353f35,0x27b1bf80,0x3f6d3ec4,0xbf353f35,0xbec4bf6d
.long 0xa6d43f80,0xbf80a777,0x27c2bf80,0x3f80258d,0xa70dbf80,0x3f6dbec4,0x3f353f35,0xbec43f6d
.long 0xa6f73f80,0xbf353f35,0xbf80a78d,0xbf35bf35,0x27c2bf80,0x3ec4bf6d,0x3f35bf35,0x3f6dbec4
.long 0x3f80,0x3f80,0x3f80,0x3f80,0xbf80a554,0xbf6d3ec4,0xbf353f35,0xbec43f6d
.long 0x25d4bf80,0xbf35bf35,0xbf80a5f7,0xbf353f35,0x3f80261f,0x3ec4bf6d,0xbf35bf35,0xbf6d3ec4
.long 0xa6543f80,0x3f80a68d,0x2677bf80,0xbf80a742,0xbf80a742,0x3ec43f6d,0x3f35bf35,0xbf6dbec4
.long 0x269fbf80,0xbf353f35,0x3f80a60d,0xbf35bf35,0x3f80a60d,0xbf6dbec4,0x3f353f35,0xbec4bf6d
.long 0xa6d43f80,0xa70dbf80,0xa6f73f80,0x27c2bf80,0xbf80a777,0x3f6dbec4,0xbf353f35,0x3ec4bf6d
.long 0x27c2bf80,0x3f353f35,0xbf80a78d,0x3f35bf35,0x3f802804,0xbec43f6d,0xbf35bf35,0x3f6dbec4
.long 0xa71f3f80,0xbf80a796,0xa68dbf80,0x3f80268d,0xbf802754,0xbec4bf6d,0x3f35bf35,0x3f6d3ec4
.long 0xa68dbf80,0x3f35bf35,0x3f802816,0x3f353f35,0x3f802889,0x3f6d3ec4,0x3f353f35,0x3ec43f6d
.long 0x3f808000,0x3f808000,0x3f808000,0x3f808000,0x3f808000,0x3f6dbec4,0x3f35bf35,0x3ec4bf6d
.long 0x3f808000,0x3f35bf35,0x248dbf80,0xbf35bf35,0x3f808000,0x3ec4bf6d,0xbf35bf35,0xbf6d3ec4
.long 0x3f808000,0x248dbf80,0xbf80a50d,0xa5543f80,0x3f808000,0xbec4bf6d,0xbf353f35,0x3f6d3ec4
.long 0x3f808000,0xbf35bf35,0xa5543f80,0x3f35bf35,0x3f808000,0xbf6dbec4,0x3f353f35,0xbec4bf6d
.long 0x3f808000,0xbf80a50d,0x3f80258d,0xbf80a5d4,0x3f808000,0xbf6d3ec4,0x3f35bf35,0xbec43f6d
.long 0x3f808000,0xbf353f35,0x25b0bf80,0x3f353f35,0x3f808000,0xbec43f6d,0xbf35bf35,0x3f6dbec4
.long 0x3f808000,0xa5543f80,0xbf80a5d4,0x261fbf80,0x3f808000,0x3ec43f6d,0xbf353f35,0xbf6dbec4
.long 0x3f808000,0x3f353f35,0xa5f73f80,0xbf353f35,0x3f808000,0x3f6d3ec4,0x3f353f35,0x3ec43f6d
.long 0x3f808000,0x3f808000,0x3f808000,0x3f808000,0x248dbf80,0xbec4bf6d,0xbf35bf35,0xbf6dbec4
.long 0xbf80a50d,0xbf353f35,0xa5543f80,0x3f353f35,0xa5543f80,0x3f6d3ec4,0x3f35bf35,0xbec4bf6d
.long 0x3f80258d,0x25b0bf80,0xbf80a5d4,0xa5f73f80,0x25b0bf80,0xbf6d3ec4,0x3f353f35,0x3ec4bf6d
.long 0xbf80a5d4,0x3f353f35,0x261fbf80,0xbf353f35,0xa5f73f80,0x3ec4bf6d,0xbf353f35,0x3f6dbec4
.long 0x3f80260d,0xbf80a630,0x3f802654,0xbf80a677,0x261fbf80,0x3ec43f6d,0xbf35bf35,0x3f6d3ec4
.long 0xbf80a630,0x3f35bf35,0xa7423f80,0xbf35bf35,0xa7313f80,0xbf6dbec4,0x3f35bf35,0x3ec43f6d
.long 0x3f802654,0xa7423f80,0xbf80a69f,0xa60dbf80,0xa68dbf80,0x3f6dbec4,0x3f353f35,0xbec43f6d
.long 0xbf80a677,0xbf35bf35,0xa60dbf80,0x3f35bf35,0xa7423f80,0xbec43f6d,0xbf353f35,0xbf6d3ec4
.long 0x3f808000,0x3f808000,0x3f808000,0x3f808000,0xbf80a50d,0xbf6d3ec4,0xbf353f35,0xbec43f6d
.long 0x3f80258d,0x3f35bf35,0x25b0bf80,0xbf35bf35,0xbf80a5d4,0xbec43f6d,0x3f353f35,0x3f6dbec4
.long 0x3f80260d,0x261fbf80,0xbf80a630,0xa7313f80,0xbf80a630,0x3ec43f6d,0x3f35bf35,0xbf6dbec4
.long 0x3f802654,0xbf35bf35,0xa7423f80,0x3f35bf35,0xbf80a677,0x3f6d3ec4,0xbf35bf35,0x3ec43f6d
.long 0x3f80268d,0xbf80a69f,0x3f8026b0,0xbf80a7b1,0xbf80a69f,0x3f6dbec4,0xbf353f35,0x3ec4bf6d
.long 0x3f8026b0,0xbf353f35,0xa58ebf80,0x3f353f35,0xbf80a7b1,0x3ec4bf6d,0x3f353f35,0xbf6d3ec4
.long 0x3f8026d4,0xa7773f80,0xbf80a7c2,0x258dbf80,0xbf80270d,0xbec4bf6d,0x3f35bf35,0x3f6d3ec4
.long 0x3f8026f7,0x3f353f35,0xa78d3f80,0xbf353f35,0xbf80a7c2,0xbf6dbec4,0xbf35bf35,0xbec4bf6d
.long 0x3f808000,0x3f808000,0x3f808000,0x3f808000,0xa5543f80,0x3ec43f6d,0x3f353f35,0x3f6d3ec4
.long 0xbf80a5d4,0xbf353f35,0xa5f73f80,0x3f353f35,0x261fbf80,0xbf6dbec4,0xbf353f35,0x3ec43f6d
.long 0x3f802654,0xa68dbf80,0xbf80a677,0xa7423f80,0xa7423f80,0x3f6dbec4,0xbf35bf35,0xbec43f6d
.long 0xbf80a69f,0x3f353f35,0xa60dbf80,0xbf353f35,0xa60dbf80,0xbec43f6d,0x3f35bf35,0xbf6d3ec4
.long 0x3f8026d4,0xbf80270d,0x3f8026f7,0xbf80a7c2,0xa7773f80,0xbec4bf6d,0x3f353f35,0xbf6dbec4
.long 0xbf80a7c2,0x3f35bf35,0xa78d3f80,0xbf35bf35,0x2804bf80,0x3f6d3ec4,0xbf353f35,0xbec4bf6d
.long 0x3f80271f,0xa7963f80,0xbf80268d,0x268dbf80,0x27543f80,0xbf6d3ec4,0xbf35bf35,0x3ec4bf6d
.long 0xbf80268d,0xbf35bf35,0x2816bf80,0x3f35bf35,0x2889bf80,0x3ec4bf6d,0x3f35bf35,0x3f6dbec4
.long 0x3f800000,0x3f800000,0x3f800000,0x3f800000,0x3f800000,0x3f7fec43,0x3f7fb10f,0x3f7f4e6d
.long 0x3f800000,0x3f7fb10f,0x3f7ec46d,0x3f7d3aac,0x3f800000,0x3f7f4e6d,0x3f7d3aac,0x3f79c79d
.long 0x3f800000,0x3f7ec46d,0x3f7b14be,0x3f74fa0b,0x3f800000,0x3f7e1324,0x3f7853f8,0x3f6ed89e
.long 0x3f800000,0x3f7d3aac,0x3f74fa0b,0x3f676bd8,0x3f800000,0x3f7c3b28,0x3f710908,0x3f5ebe05
.long 0x3f800000,0x3f7b14be,0x3f6c835e,0x3f54db31,0x3f800000,0x3f79c79d,0x3f676bd8,0x3f49d112
.long 0x3f800000,0x3f7853f8,0x3f61c598,0x3f3daef9,0x3f800000,0x3f76ba07,0x3f5b941a,0x3f3085bb
.long 0x3f800000,0x3f74fa0b,0x3f54db31,0x3f226799,0x3f800000,0x3f731447,0x3f4d9f02,0x3f13682a
.long 0x3f800000,0x3f710908,0x3f45e403,0x3f039c3d,0x3f800000,0x3f6ed89e,0x3f3daef9,0x3ee63375
.long 0x3f800000,0x3f800000,0x3f800000,0x3f800000,0x3f7ec46d,0x3f7e1324,0x3f7d3aac,0x3f7c3b28
.long 0x3f7b14be,0x3f7853f8,0x3f74fa0b,0x3f710908,0x3f74fa0b,0x3f6ed89e,0x3f676bd8,0x3f5ebe05
.long 0x3f6c835e,0x3f61c598,0x3f54db31,0x3f45e403,0x3f61c598,0x3f514d3d,0x3f3daef9,0x3f273656
.long 0x3f54db31,0x3f3daef9,0x3f226799,0x3f039c3d,0x3f45e403,0x3f273656,0x3f039c3d,0x3eb8442a
.long 0x3f3504f3,0x3f0e39da,0x3ec3ef15,0x3e47c5c2,0x3f226799,0x3ee63375,0x3e78cfcc,0x3cc90ab0
.long 0x3f0e39da,0x3eac7cd4,0x3dc8bd36,0xbe164083,0x3ef15aea,0x3e605c13,0xbd48fb30,0xbea09ae5
.long 0x3ec3ef15,0x3dc8bd36,0xbe47c5c2,0xbef15aea,0x3e94a031,0xbcc90ab0,0xbeac7cd4,0xbf1d7fd1
.long 0x3e47c5c2,0xbe164083,0xbef15aea,0xbf3daef9,0x3dc8bd36,0xbe888e93,0xbf187fc0,0xbf584853
.long 0x3f800000,0x3f800000,0x3f800000,0x3f800000,0x3f7b14be,0x3f79c79d,0x3f7853f8,0x3f76ba07
.long 0x3f6c835e,0x3f676bd8,0x3f61c598,0x3f5b941a,0x3f54db31,0x3f49d112,0x3f3daef9,0x3f3085bb
.long 0x3f3504f3,0x3f226799,0x3f0e39da,0x3ef15aea,0x3f0e39da,0x3ee63375,0x3eac7cd4,0x3e605c13
.long 0x3ec3ef15,0x3e78cfcc,0x3dc8bd36,0xbd48fb30,0x3e47c5c2,0x3cc90ab0,0xbe164083,0xbea09ae5
.long 0x248d3132,0xbe47c5c2,0xbec3ef15,0xbf0e39da,0xbe47c5c2,0xbecf7bca,0xbf187fc0,0xbf41d870
.long 0xbec3ef15,0xbf187fc0,0xbf45e403,0xbf676bd8,0xbf0e39da,0xbf41d870,0xbf676bd8,0xbf7c3b28
.long 0xbf3504f3,0xbf61c598,0xbf7b14be,0xbf7ec46d,0xbf54db31,0xbf76ba07,0xbf7fb10f,0xbf6ed89e
.long 0xbf6c835e,0xbf7fb10f,0xbf74fa0b,0xbf4d9f02,0xbf7b14be,0xbf7c3b28,0xbf5b941a,0xbf1d7fd1
.long 0x3f800000,0x3f800000,0x3f800000,0x3f800000,0x3f74fa0b,0x3f731447,0x3f710908,0x3f6ed89e
.long 0x3f54db31,0x3f4d9f02,0x3f45e403,0x3f3daef9,0x3f226799,0x3f13682a,0x3f039c3d,0x3ee63375
.long 0x3ec3ef15,0x3e94a031,0x3e47c5c2,0x3dc8bd36,0x3dc8bd36,0xbcc90ab0,0xbe164083,0xbe888e93
.long 0xbe47c5c2,0xbeac7cd4,0xbef15aea,0xbf187fc0,0xbef15aea,0xbf1d7fd1,0xbf3daef9,0xbf584853
.long 0xbf3504f3,0xbf54db31,0xbf6c835e,0xbf7b14be,0xbf61c598,0xbf76ba07,0xbf7fb10f,0xbf7c3b28
.long 0xbf7b14be,0xbf7fb10f,0xbf74fa0b,0xbf5b941a,0xbf7ec46d,0xbf6ed89e,0xbf4d9f02,0xbf1d7fd1
.long 0xbf6c835e,0xbf45e403,0xbf0e39da,0xbe94a031,0xbf45e403,0xbf08f59b,0xbe78cfcc,0x3d96a905
.long 0xbf0e39da,0xbe78cfcc,0x3dc8bd36,0x3edae880,0xbe94a031,0x3d96a905,0x3edae880,0x3f396842
.long 0x0,0x0,0x0,0x0,0x0,0x3cc90ab0,0x3d48fb30,0x3d96a905
.long 0x0,0x3d48fb30,0x3dc8bd36,0x3e164083,0x0,0x3d96a905,0x3e164083,0x3e605c13
.long 0x0,0x3dc8bd36,0x3e47c5c2,0x3e94a031,0x0,0x3dfab273,0x3e78cfcc,0x3eb8442a
.long 0x0,0x3e164083,0x3e94a031,0x3edae880,0x0,0x3e2f10a2,0x3eac7cd4,0x3efc5d27
.long 0x0,0x3e47c5c2,0x3ec3ef15,0x3f0e39da,0x0,0x3e605c13,0x3edae880,0x3f1d7fd1
.long 0x0,0x3e78cfcc,0x3ef15aea,0x3f2beb4a,0x0,0x3e888e93,0x3f039c3d,0x3f396842
.long 0x0,0x3e94a031,0x3f0e39da,0x3f45e403,0x0,0x3ea09ae5,0x3f187fc0,0x3f514d3d
.long 0x0,0x3eac7cd4,0x3f226799,0x3f5b941a,0x0,0x3eb8442a,0x3f2beb4a,0x3f64aa59
.long 0x0,0x0,0x0,0x0,0x3dc8bd36,0x3dfab273,0x3e164083,0x3e2f10a2
.long 0x3e47c5c2,0x3e78cfcc,0x3e94a031,0x3eac7cd4,0x3e94a031,0x3eb8442a,0x3edae880,0x3efc5d27
.long 0x3ec3ef15,0x3ef15aea,0x3f0e39da,0x3f226799,0x3ef15aea,0x3f13682a,0x3f2beb4a,0x3f41d870
.long 0x3f0e39da,0x3f2beb4a,0x3f45e403,0x3f5b941a,0x3f226799,0x3f41d870,0x3f5b941a,0x3f6ed89e
.long 0x3f3504f3,0x3f54db31,0x3f6c835e,0x3f7b14be,0x3f45e403,0x3f64aa59,0x3f7853f8,0x3f7fec43
.long 0x3f54db31,0x3f710908,0x3f7ec46d,0x3f7d3aac,0x3f61c598,0x3f79c79d,0x3f7fb10f,0x3f731447
.long 0x3f6c835e,0x3f7ec46d,0x3f7b14be,0x3f61c598,0x3f74fa0b,0x3f7fec43,0x3f710908,0x3f49d112
.long 0x3f7b14be,0x3f7d3aac,0x3f61c598,0x3f2beb4a,0x3f7ec46d,0x3f76ba07,0x3f4d9f02,0x3f08f59b
.long 0x0,0x0,0x0,0x0,0x3e47c5c2,0x3e605c13,0x3e78cfcc,0x3e888e93
.long 0x3ec3ef15,0x3edae880,0x3ef15aea,0x3f039c3d,0x3f0e39da,0x3f1d7fd1,0x3f2beb4a,0x3f396842
.long 0x3f3504f3,0x3f45e403,0x3f54db31,0x3f61c598,0x3f54db31,0x3f64aa59,0x3f710908,0x3f79c79d
.long 0x3f6c835e,0x3f7853f8,0x3f7ec46d,0x3f7fb10f,0x3f7b14be,0x3f7fec43,0x3f7d3aac,0x3f731447
.long 0x3f800000,0x3f7b14be,0x3f6c835e,0x3f54db31,0x3f7b14be,0x3f6a09a7,0x3f4d9f02,0x3f273656
.long 0x3f6c835e,0x3f4d9f02,0x3f226799,0x3edae880,0x3f54db31,0x3f273656,0x3edae880,0x3e2f10a2
.long 0x3f3504f3,0x3ef15aea,0x3e47c5c2,0xbdc8bd36,0x3f0e39da,0x3e888e93,0xbd48fb30,0xbeb8442a
.long 0x3ec3ef15,0x3d48fb30,0xbe94a031,0xbf187fc0,0x3e47c5c2,0xbe2f10a2,0xbf039c3d,0xbf49d112
.long 0x0,0x0,0x0,0x0,0x3e94a031,0x3ea09ae5,0x3eac7cd4,0x3eb8442a
.long 0x3f0e39da,0x3f187fc0,0x3f226799,0x3f2beb4a,0x3f45e403,0x3f514d3d,0x3f5b941a,0x3f64aa59
.long 0x3f6c835e,0x3f74fa0b,0x3f7b14be,0x3f7ec46d,0x3f7ec46d,0x3f7fec43,0x3f7d3aac,0x3f76ba07
.long 0x3f7b14be,0x3f710908,0x3f61c598,0x3f4d9f02,0x3f61c598,0x3f49d112,0x3f2beb4a,0x3f08f59b
.long 0x3f3504f3,0x3f0e39da,0x3ec3ef15,0x3e47c5c2,0x3ef15aea,0x3e888e93,0x3d48fb30,0xbe2f10a2
.long 0x3e47c5c2,0xbd48fb30,0xbe94a031,0xbf039c3d,0xbdc8bd36,0xbeb8442a,0xbf187fc0,0xbf49d112
.long 0xbec3ef15,0xbf226799,0xbf54db31,0xbf74fa0b,0xbf226799,0xbf584853,0xbf7853f8,0xbf7f4e6d
.long 0xbf54db31,0xbf7853f8,0xbf7ec46d,0xbf676bd8,0xbf74fa0b,0xbf7f4e6d,0xbf676bd8,0xbf3085bb
.long 0x3020100,0x3020100,0x3020100,0x3020100,0x3020100,0x3020100,0x0,0x0
.long 0x3020100,0x3020100,0x3020100,0x3020100,0x3020100,0x3020100,0x0,0x0
.long 0x3020100,0x3020100,0x3020100,0x3020100,0x3020100,0x3020100,0x0,0x0
.long 0x3020100,0x3020100,0x3020100,0x3020100,0x3020100,0x3020100,0x0,0x0
.long 0x3020100,0x3020100,0x3020100,0x3020100,0x3020100,0x3020100,0x0,0x0
.long 0x3020100,0x3020100,0x3020100,0x3020100,0x3020100,0x3020100,0x0,0x0
.long 0x3020100,0x3020100,0x3020100,0x3020100,0x3020100,0x3020100,0x0,0x0
.long 0x3020100,0x3020100,0x3020100,0x3020100,0x3020100,0x3020100,0x0,0x0
.long 0x3020100,0x3020100,0x3020100,0x3020100,0x3020100,0x3020100,0x0,0x0
.long 0x3020100,0x3020100,0x3020100,0x3020100,0x3020100,0x3020100,0x0,0x0
.long 0x3020100,0x3020100,0x3020100,0x3020100,0x3020100,0x3020100,0x0,0x0
.long 0x3020100,0x3020100,0x3020100,0x3020100,0x3020100,0x3020100,0x0,0x0
.long 0x3020100,0x3020100,0x3020100,0x3020100,0x3020100,0x3020100,0x0,0x0
.long 0x3020100,0x3020100,0x3020100,0x3020100,0x3020100,0x3020100,0x0,0x0
.long 0x3020100,0x3020100,0x3020100,0x3020100,0x3020100,0x3020100,0x0,0x0
.long 0x3020100,0x3020100,0x3020100,0x3020100,0x3020100,0x3020100,0x0,0x0
.long 0x3020100,0x3020100,0x3020100,0x3020100,0x3020100,0x3020100,0x0,0x0
.long 0x3020100,0x3020100,0x3020100,0x3020100,0x3020100,0x3020100,0x0,0x0
.long 0x3020100,0x3020100,0x3020100,0x3020100,0x3020100,0x3020100,0x0,0x0
.long 0x3020100,0x3020100,0x3020100,0x3020100,0x3020100,0x3020100,0x0,0x0
.long 0x3020100,0x3020100,0x3020100,0x3020100,0x3020100,0x3020100,0x0,0x0
.long 0x3020100,0x3020100,0x3020100,0x3020100,0x3020100,0x3020100,0x0,0x0
.long 0x3020100,0x3020100,0x3020100,0x3020100,0x3020100,0x3020100,0x0,0x0
.long 0x3020100,0x3020100,0x3020100,0x3020100,0x3020100,0x3020100,0x0,0x0
.long 0x3020100,0x3020100,0x3020100,0x3020100,0x3020100,0x3020100,0x0,0x0
.long 0x3020100,0x3020100,0x3020100,0x3020100,0x3020100,0x3020100,0x0,0x0
.long 0x3020100,0x3020100,0x3020100,0x3020100,0x3020100,0x3020100,0x0,0x0
.long 0x3020100,0x3020100,0x3020100,0x3020100,0x3020100,0x3020100,0x0,0x0
.long 0x3020100,0x3020100,0x3020100,0x3020100,0x3020100,0x3020100,0x0,0x0
.long 0x3020100,0x3020100,0x3020100,0x3020100,0x3020100,0x3020100,0x0,0x0
.long 0x3020100,0x3020100,0x3020100,0x3020100,0x3020100,0x3020100,0x0,0x0
.long 0x3020100,0x3020100,0x3020100,0x3020100,0x3020100,0x3020100,0x0,0x0
.long 0x3020100,0x3020100,0x1000100,0x5040100,0x1000100,0x5040100,0x0,0x0
.long 0x1000100,0x5040100,0x1000100,0x5040100,0x1000100,0x5040100,0x0,0x0
.long 0x1000100,0x5040100,0x1000100,0x5040100,0x1000100,0x5040100,0x0,0x0
.long 0x1000100,0x5040100,0x1000100,0x5040100,0x1000100,0x5040100,0x0,0x0
.long 0x1000100,0x5040100,0x1000100,0x5040100,0x1000100,0x5040100,0x0,0x0
.long 0x1000100,0x5040100,0x1000100,0x5040100,0x1000100,0x5040100,0x0,0x0
.long 0x1000100,0x5040100,0x1000100,0x5040100,0x1000100,0x5040100,0x0,0x0
.long 0x1000100,0x5040100,0x1000100,0x5040100,0x1000100,0x5040100,0x0,0x0
.long 0x1000100,0x5040100,0x1000100,0x5040100,0x1000100,0x5040100,0x0,0x0
.long 0x1000100,0x5040100,0x1000100,0x5040100,0x1000100,0x5040100,0x0,0x0
.long 0x1000100,0x5040100,0x1000100,0x5040100,0x1000100,0x5040100,0x0,0x0
.long 0x1000100,0x5040100,0x1000100,0x5040100,0x1000100,0x5040100,0x0,0x0
.long 0x1000100,0x5040100,0x1000100,0x5040100,0x1000100,0x5040100,0x0,0x0
.long 0x1000100,0x5040100,0x1000100,0x5040100,0x1000100,0x5040100,0x0,0x0
.long 0x1000100,0x5040100,0x1000100,0x5040100,0x1000100,0x5040100,0x0,0x0
.long 0x1000100,0x5040100,0x1000100,0x5040100,0x1000100,0x5040100,0x0,0x0
.long 0x1000100,0x5040100,0x1000100,0x5040100,0x1000100,0x5040100,0x0,0x0
.long 0x1000100,0x5040100,0x1000100,0x5040100,0x1000100,0x5040100,0x0,0x0
.long 0x1000100,0x5040100,0x1000100,0x5040100,0x1000100,0x5040100,0x0,0x0
.long 0x1000100,0x5040100,0x1000100,0x5040100,0x1000100,0x5040100,0x0,0x0
.long 0x1000100,0x5040100,0x1000100,0x5040100,0x1000100,0x5040100,0x0,0x0
.long 0x1000100,0x5040100,0x1000100,0x5040100,0x1000100,0x5040100,0x0,0x0
.long 0x1000100,0x5040100,0x1000100,0x5040100,0x1000100,0x5040100,0x0,0x0
.long 0x1000100,0x5040100,0x1000100,0x5040100,0x1000100,0x5040100,0x0,0x0
.long 0x1000100,0x5040100,0x1000100,0x5040100,0x1000100,0x5040100,0x0,0x0
.long 0x1000100,0x5040100,0x1000100,0x5040100,0x1000100,0x5040100,0x0,0x0
.long 0x1000100,0x5040100,0x1000100,0x5040100,0x1000100,0x5040100,0x0,0x0
.long 0x1000100,0x5040100,0x1000100,0x5040100,0x1000100,0x5040100,0x0,0x0
.long 0x1000100,0x5040100,0x1000100,0x5040100,0x1000100,0x5040100,0x0,0x0
.long 0x1000100,0x5040100,0x1000100,0x5040100,0x1000100,0x5040100,0x0,0x0
.long 0x1000100,0x5040100,0x1000100,0x5040100,0x1000100,0x5040100,0x0,0x0
.long 0x1000100,0x5040100,0x1000100,0x5040100,0x1000100,0x5040100,0x0,0x0
.long 0x1000100,0x5040100,0x1000100,0x5040100,0x1000100,0x5040504,0x0,0x0
.long 0x1000100,0x5040504,0x1000100,0x5040100,0x1000100,0x5040504,0x0,0x0
.long 0x1000100,0x5040504,0x1000100,0x5040100,0x1000100,0x5040504,0x0,0x0
.long 0x1000100,0x5040504,0x1000100,0x5040100,0x1000100,0x5040504,0x0,0x0
.long 0x1000100,0x5040504,0x1000100,0x5040100,0x1000100,0x5040504,0x0,0x0
.long 0x1000100,0x5040504,0x1000100,0x5040100,0x1000100,0x5040504,0x0,0x0
.long 0x1000100,0x5040504,0x1000100,0x5040100,0x1000100,0x5040504,0x0,0x0
.long 0x1000100,0x5040504,0x1000100,0x5040100,0x1000100,0x5040504,0x0,0x0
.long 0x1000100,0x5040504,0x1000100,0x5040100,0x1000100,0x5040504,0x0,0x0
.long 0x1000100,0x5040504,0x1000100,0x5040100,0x1000100,0x5040504,0x0,0x0
.long 0x1000100,0x5040504,0x1000100,0x5040100,0x1000100,0x5040504,0x0,0x0
.long 0x1000100,0x5040504,0x1000100,0x5040100,0x1000100,0x5040504,0x0,0x0
.long 0x1000100,0x5040504,0x1000100,0x5040100,0x1000100,0x5040504,0x0,0x0
.long 0x1000100,0x5040504,0x1000100,0x5040100,0x1000100,0x5040504,0x0,0x0
.long 0x1000100,0x5040504,0x1000100,0x5040100,0x1000100,0x5040504,0x0,0x0
.long 0x1000100,0x5040504,0x1000100,0x5040100,0x1000100,0x5040504,0x0,0x0
.long 0x1000100,0x5040504,0x1000100,0x5040100,0x1000100,0x5040504,0x0,0x0
.long 0x1000100,0x5040504,0x1000100,0x5040100,0x1000100,0x5040504,0x0,0x0
.long 0x1000100,0x5040504,0x1000100,0x5040100,0x1000100,0x5040504,0x0,0x0
.long 0x1000100,0x5040504,0x1000100,0x5040100,0x1000100,0x5040504,0x0,0x0
.long 0x1000100,0x5040504,0x1000100,0x5040100,0x1000100,0x5040504,0x0,0x0
.long 0x1000100,0x5040504,0x1000100,0x5040100,0x1000100,0x5040504,0x0,0x0
.long 0x1000100,0x5040504,0x1000100,0x5040100,0x1000100,0x5040504,0x0,0x0
.long 0x1000100,0x5040504,0x1000100,0x5040100,0x1000100,0x5040504,0x0,0x0
.long 0x1000100,0x5040504,0x1000100,0x5040100,0x1000100,0x5040504,0x0,0x0
.long 0x1000100,0x5040504,0x1000100,0x5040100,0x1000100,0x5040504,0x0,0x0
.long 0x1000100,0x5040504,0x1000100,0x5040100,0x1000100,0x5040504,0x0,0x0
.long 0x1000100,0x5040504,0x1000100,0x5040100,0x1000100,0x5040504,0x0,0x0
.long 0x1000100,0x5040504,0x1000100,0x5040100,0x1000100,0x5040504,0x0,0x0
.long 0x1000100,0x5040504,0x1000100,0x5040100,0x1000100,0x5040504,0x0,0x0
.long 0x1000100,0x5040504,0x1000100,0x5040100,0x1000100,0x5040504,0x0,0x0
.long 0x1000100,0x5040504,0x1000100,0x5040100,0x1000100,0x5040504,0x0,0x0
.long 0x1000100,0x5040504,0x1000100,0x5040100,0x1000100,0x5040504,0x0,0x0
.long 0x1000100,0x5040504,0x1000100,0x5040100,0x1000100,0x5040504,0x0,0x0
.long 0x1000100,0x5040504,0x1000100,0x5040100,0x1000100,0x5040504,0x0,0x0
.long 0x1000100,0x5040504,0x1000100,0x5040100,0x1000100,0x5040504,0x0,0x0
.long 0x1000100,0x5040504,0x1000100,0x5040100,0x1000100,0x5040504,0x0,0x0
.long 0x1000100,0x5040504,0x1000100,0x5040100,0x1000100,0x5040504,0x0,0x0
.long 0x1000100,0x5040504,0x1000100,0x5040100,0x1000100,0x5040504,0x0,0x0
.long 0x1000100,0x5040504,0x1000100,0x5040100,0x1000100,0x5040504,0x0,0x0
.long 0x1000100,0x5040504,0x1000100,0x5040100,0x1000100,0x5040504,0x0,0x0
.long 0x1000100,0x5040504,0x1000100,0x5040100,0x1000100,0x5040504,0x0,0x0
.long 0x1000100,0x5040504,0x1000100,0x5040100,0x1000100,0x5040504,0x0,0x0
.long 0x1000100,0x5040504,0x1000100,0x5040100,0x1000100,0x5040504,0x0,0x0
.long 0x1000100,0x5040504,0x1000100,0x5040100,0x1000100,0x5040504,0x0,0x0
.long 0x1000100,0x5040504,0x1000100,0x5040100,0x1000100,0x5040504,0x0,0x0
.long 0x1000100,0x5040504,0x1000100,0x5040100,0x1000100,0x5040504,0x0,0x0
.long 0x1000100,0x5040504,0x1000100,0x5040100,0x1000100,0x5040504,0x0,0x0
.long 0x1000100,0x5040504,0x1000100,0x5040100,0x1000100,0x5040504,0x0,0x0
.long 0x1000100,0x5040504,0x1000100,0x5040100,0x1000100,0x5040504,0x0,0x0
.long 0x1000100,0x5040504,0x1000100,0x5040100,0x1000100,0x5040504,0x0,0x0
.long 0x1000100,0x5040504,0x1000100,0x5040100,0x1000100,0x5040504,0x0,0x0
.long 0x1000100,0x5040504,0x1000100,0x5040100,0x1000100,0x5040504,0x0,0x0
.long 0x1000100,0x5040504,0x1000100,0x5040100,0x1000100,0x5040504,0x0,0x0
.long 0x1000100,0x5040504,0x1000100,0x5040100,0x1000100,0x5040504,0x0,0x0
.long 0x1000100,0x5040504,0x1000100,0x5040100,0x1000100,0x5040504,0x0,0x0
.long 0x1000100,0x5040504,0x1000100,0x5040100,0x1000100,0x5040504,0x0,0x0
.long 0x1000100,0x5040504,0x1000100,0x5040100,0x1000100,0x5040504,0x0,0x0
.long 0x1000100,0x5040504,0x1000100,0x5040100,0x1000100,0x5040504,0x0,0x0
.long 0x1000100,0x5040504,0x1000100,0x5040100,0x1000100,0x5040504,0x0,0x0
.long 0x1000100,0x5040504,0x1000100,0x5040100,0x1000100,0x5040504,0x0,0x0
.long 0x1000100,0x5040504,0x1000100,0x5040100,0x1000100,0x5040504,0x0,0x0
.long 0x1000100,0x5040504,0x1000100,0x5040100,0x1000100,0x5040504,0x0,0x0
.long 0x1000100,0x5040504,0x1000100,0x5040100,0x1000100,0x5040504,0x0,0x0
.long 0x1000100,0x5040504,0x1000100,0x1000100,0x5040100,0x5040504,0x0,0x0
.long 0x5040100,0x5040504,0x1000100,0x1000100,0x5040504,0x5040504,0x0,0x0
.long 0x5040504,0x5040504,0x1000100,0x1000100,0x5040100,0x5040504,0x0,0x0
.long 0x5040100,0x5040504,0x1000100,0x1000100,0x5040504,0x5040504,0x0,0x0
.long 0x5040504,0x5040504,0x1000100,0x1000100,0x5040100,0x5040504,0x0,0x0
.long 0x5040100,0x5040504,0x1000100,0x1000100,0x5040504,0x5040504,0x0,0x0
.long 0x5040504,0x5040504,0x1000100,0x1000100,0x5040100,0x5040504,0x0,0x0
.long 0x5040100,0x5040504,0x1000100,0x1000100,0x5040504,0x5040504,0x0,0x0
.long 0x5040504,0x5040504,0x1000100,0x1000100,0x5040100,0x5040504,0x0,0x0
.long 0x5040100,0x5040504,0x1000100,0x1000100,0x5040504,0x5040504,0x0,0x0
.long 0x5040504,0x5040504,0x1000100,0x1000100,0x5040100,0x5040504,0x0,0x0
.long 0x5040100,0x5040504,0x1000100,0x1000100,0x5040504,0x5040504,0x0,0x0
.long 0x5040504,0x5040504,0x1000100,0x1000100,0x5040100,0x5040504,0x0,0x0
.long 0x5040100,0x5040504,0x1000100,0x1000100,0x5040504,0x5040504,0x0,0x0
.long 0x5040504,0x5040504,0x1000100,0x1000100,0x5040100,0x5040504,0x0,0x0
.long 0x5040100,0x5040504,0x1000100,0x1000100,0x5040504,0x5040504,0x0,0x0
.long 0x5040504,0x5040504,0x1000100,0x1000100,0x5040100,0x5040504,0x0,0x0
.long 0x5040100,0x5040504,0x1000100,0x1000100,0x5040504,0x5040504,0x0,0x0
.long 0x5040504,0x5040504,0x1000100,0x1000100,0x5040100,0x5040504,0x0,0x0
.long 0x5040100,0x5040504,0x1000100,0x1000100,0x5040504,0x5040504,0x0,0x0
.long 0x5040504,0x5040504,0x1000100,0x1000100,0x5040100,0x5040504,0x0,0x0
.long 0x5040100,0x5040504,0x1000100,0x1000100,0x5040504,0x5040504,0x0,0x0
.long 0x5040504,0x5040504,0x1000100,0x1000100,0x5040100,0x5040504,0x0,0x0
.long 0x5040100,0x5040504,0x1000100,0x1000100,0x5040504,0x5040504,0x0,0x0
.long 0x5040504,0x5040504,0x1000100,0x1000100,0x5040100,0x5040504,0x0,0x0
.long 0x5040100,0x5040504,0x1000100,0x1000100,0x5040504,0x5040504,0x0,0x0
.long 0x5040504,0x5040504,0x1000100,0x1000100,0x5040100,0x5040504,0x0,0x0
.long 0x5040100,0x5040504,0x1000100,0x1000100,0x5040504,0x5040504,0x0,0x0
.long 0x5040504,0x5040504,0x1000100,0x1000100,0x5040100,0x5040504,0x0,0x0
.long 0x5040100,0x5040504,0x1000100,0x1000100,0x5040504,0x5040504,0x0,0x0
.long 0x5040504,0x5040504,0x1000100,0x1000100,0x5040100,0x5040504,0x0,0x0
.long 0x5040100,0x5040504,0x1000100,0x1000100,0x5040504,0x5040504,0x0,0x0
.long 0x5040504,0x5040504,0x1000100,0x1000100,0x5040100,0x5040504,0x0,0x0
.long 0x5040100,0x5040504,0x1000100,0x1000100,0x5040504,0x5040504,0x0,0x0
.long 0x5040504,0x5040504,0x1000100,0x1000100,0x5040100,0x5040504,0x0,0x0
.long 0x5040100,0x5040504,0x1000100,0x1000100,0x5040504,0x5040504,0x0,0x0
.long 0x5040504,0x5040504,0x1000100,0x1000100,0x5040100,0x5040504,0x0,0x0
.long 0x5040100,0x5040504,0x1000100,0x1000100,0x5040504,0x5040504,0x0,0x0
.long 0x5040504,0x5040504,0x1000100,0x1000100,0x5040100,0x5040504,0x0,0x0
.long 0x5040100,0x5040504,0x1000100,0x1000100,0x5040504,0x5040504,0x0,0x0
.long 0x5040504,0x5040504,0x1000100,0x1000100,0x5040100,0x5040504,0x0,0x0
.long 0x5040100,0x5040504,0x1000100,0x1000100,0x5040504,0x5040504,0x0,0x0
.long 0x5040504,0x5040504,0x1000100,0x1000100,0x5040100,0x5040504,0x0,0x0
.long 0x5040100,0x5040504,0x1000100,0x1000100,0x5040504,0x5040504,0x0,0x0
.long 0x5040504,0x5040504,0x1000100,0x1000100,0x5040100,0x5040504,0x0,0x0
.long 0x5040100,0x5040504,0x1000100,0x1000100,0x5040504,0x5040504,0x0,0x0
.long 0x5040504,0x5040504,0x1000100,0x1000100,0x5040100,0x5040504,0x0,0x0
.long 0x5040100,0x5040504,0x1000100,0x1000100,0x5040504,0x5040504,0x0,0x0
.long 0x5040504,0x5040504,0x1000100,0x1000100,0x5040100,0x5040504,0x0,0x0
.long 0x5040100,0x5040504,0x1000100,0x1000100,0x5040504,0x5040504,0x0,0x0
.long 0x5040504,0x5040504,0x1000100,0x1000100,0x5040100,0x5040504,0x0,0x0
.long 0x5040100,0x5040504,0x1000100,0x1000100,0x5040504,0x5040504,0x0,0x0
.long 0x5040504,0x5040504,0x1000100,0x1000100,0x5040100,0x5040504,0x0,0x0
.long 0x5040100,0x5040504,0x1000100,0x1000100,0x5040504,0x5040504,0x0,0x0
.long 0x5040504,0x5040504,0x1000100,0x1000100,0x5040100,0x5040504,0x0,0x0
.long 0x5040100,0x5040504,0x1000100,0x1000100,0x5040504,0x5040504,0x0,0x0
.long 0x5040504,0x5040504,0x1000100,0x1000100,0x5040100,0x5040504,0x0,0x0
.long 0x5040100,0x5040504,0x1000100,0x1000100,0x5040504,0x5040504,0x0,0x0
.long 0x5040504,0x5040504,0x1000100,0x1000100,0x5040100,0x5040504,0x0,0x0
.long 0x5040100,0x5040504,0x1000100,0x1000100,0x5040504,0x5040504,0x0,0x0
.long 0x5040504,0x5040504,0x1000100,0x1000100,0x5040100,0x5040504,0x0,0x0
.long 0x5040100,0x5040504,0x1000100,0x1000100,0x5040504,0x5040504,0x0,0x0
.long 0x5040504,0x5040504,0x1000100,0x1000100,0x5040100,0x5040504,0x0,0x0
.long 0x5040100,0x5040504,0x1000100,0x1000100,0x5040504,0x5040504,0x0,0x0
.long 0x5040504,0x5040504,0x1000100,0x1000100,0x5040100,0x5040504,0x0,0x0
.long 0x5040100,0x5040504,0x1000100,0x1000100,0x5040504,0x5040504,0x0,0x0
.long 0x5040504,0x5040504,0x1000100,0x1000100,0x5040100,0x5040504,0x0,0x0
.long 0x5040100,0x5040504,0x1000100,0x1000100,0x5040504,0x5040504,0x0,0x0
.long 0x5040504,0x5040504,0x1000100,0x1000100,0x5040100,0x5040504,0x0,0x0
.long 0x5040100,0x5040504,0x1000100,0x1000100,0x5040504,0x5040504,0x0,0x0
.long 0x5040504,0x5040504,0x1000100,0x1000100,0x5040100,0x5040504,0x0,0x0
.long 0x5040100,0x5040504,0x1000100,0x1000100,0x5040504,0x5040504,0x0,0x0
.long 0x5040504,0x5040504,0x1000100,0x1000100,0x5040100,0x5040504,0x0,0x0
.long 0x5040100,0x5040504,0x1000100,0x1000100,0x5040504,0x5040504,0x0,0x0
.long 0x5040504,0x5040504,0x1000100,0x1000100,0x5040100,0x5040504,0x0,0x0
.long 0x5040100,0x5040504,0x1000100,0x1000100,0x5040504,0x5040504,0x0,0x0
.long 0x5040504,0x5040504,0x1000100,0x1000100,0x5040100,0x5040504,0x0,0x0
.long 0x5040100,0x5040504,0x1000100,0x1000100,0x5040504,0x5040504,0x0,0x0
.long 0x5040504,0x5040504,0x1000100,0x1000100,0x5040100,0x5040504,0x0,0x0
.long 0x5040100,0x5040504,0x1000100,0x1000100,0x5040504,0x5040504,0x0,0x0
.long 0x5040504,0x5040504,0x1000100,0x1000100,0x5040100,0x5040504,0x0,0x0
.long 0x5040100,0x5040504,0x1000100,0x1000100,0x5040504,0x5040504,0x0,0x0
.long 0x5040504,0x5040504,0x1000100,0x1000100,0x5040100,0x5040504,0x0,0x0
.long 0x5040100,0x5040504,0x1000100,0x1000100,0x5040504,0x5040504,0x0,0x0
.long 0x5040504,0x5040504,0x1000100,0x1000100,0x5040100,0x5040504,0x0,0x0
.long 0x5040100,0x5040504,0x1000100,0x1000100,0x5040504,0x5040504,0x0,0x0
.long 0x5040504,0x5040504,0x1000100,0x1000100,0x5040100,0x5040504,0x0,0x0
.long 0x5040100,0x5040504,0x1000100,0x1000100,0x5040504,0x5040504,0x0,0x0
.long 0x5040504,0x5040504,0x1000100,0x1000100,0x5040100,0x5040504,0x0,0x0
.long 0x5040100,0x5040504,0x1000100,0x1000100,0x5040504,0x5040504,0x0,0x0
.long 0x5040504,0x5040504,0x1000100,0x1000100,0x5040100,0x5040504,0x0,0x0
.long 0x5040100,0x5040504,0x1000100,0x1000100,0x5040504,0x5040504,0x0,0x0
.long 0x5040504,0x5040504,0x1000100,0x1000100,0x5040100,0x5040504,0x0,0x0
.long 0x5040100,0x5040504,0x1000100,0x1000100,0x5040504,0x5040504,0x0,0x0
.long 0x5040504,0x5040504,0x1000100,0x1000100,0x5040100,0x5040504,0x0,0x0
.long 0x5040100,0x5040504,0x1000100,0x1000100,0x5040504,0x5040504,0x0,0x0
.long 0x5040504,0x5040504,0x1000100,0x1000100,0x5040100,0x5040504,0x0,0x0
.long 0x5040100,0x5040504,0x1000100,0x1000100,0x5040504,0x5040504,0x0,0x0
.long 0x5040504,0x5040504,0x1000100,0x1000100,0x5040100,0x5040504,0x0,0x0
.long 0x5040100,0x5040504,0x1000100,0x1000100,0x5040504,0x5040504,0x0,0x0
.long 0x5040504,0x5040504,0x1000100,0x1000100,0x5040100,0x5040504,0x0,0x0
.long 0x5040100,0x5040504,0x1000100,0x1000100,0x5040504,0x5040504,0x0,0x0
.long 0x5040504,0x5040504,0x1000100,0x1000100,0x5040100,0x5040504,0x0,0x0
.long 0x5040100,0x5040504,0x1000100,0x1000100,0x5040504,0x5040504,0x0,0x0
.long 0x5040504,0x5040504,0x1000100,0x1000100,0x5040100,0x5040504,0x0,0x0
.long 0x5040100,0x5040504,0x1000100,0x1000100,0x5040504,0x5040504,0x0,0x0
.long 0x5040504,0x5040504,0x1000100,0x1000100,0x5040100,0x5040504,0x0,0x0
.long 0x5040100,0x5040504,0x1000100,0x1000100,0x5040504,0x5040504,0x0,0x0
.long 0x5040504,0x5040504,0x1000100,0x1000100,0x5040100,0x5040504,0x0,0x0
.long 0x5040100,0x5040504,0x1000100,0x1000100,0x5040504,0x5040504,0x0,0x0
.long 0x5040504,0x5040504,0x1000100,0x1000100,0x5040100,0x5040504,0x0,0x0
.long 0x5040100,0x5040504,0x1000100,0x1000100,0x5040504,0x5040504,0x0,0x0
.long 0x5040504,0x5040504,0x1000100,0x1000100,0x5040100,0x5040504,0x0,0x0
.long 0x5040100,0x5040504,0x1000100,0x1000100,0x5040504,0x5040504,0x0,0x0
.long 0x5040504,0x5040504,0x1000100,0x1000100,0x5040100,0x5040504,0x0,0x0
.long 0x5040100,0x5040504,0x1000100,0x1000100,0x5040504,0x5040504,0x0,0x0
.long 0x5040504,0x5040504,0x1000100,0x1000100,0x5040100,0x5040504,0x0,0x0
.long 0x5040100,0x5040504,0x1000100,0x1000100,0x5040504,0x5040504,0x0,0x0
.long 0x5040504,0x5040504,0x1000100,0x1000100,0x5040100,0x5040504,0x0,0x0
.long 0x5040100,0x5040504,0x1000100,0x1000100,0x5040504,0x5040504,0x0,0x0
.long 0x5040504,0x5040504,0x1000100,0x1000100,0x5040100,0x5040504,0x0,0x0
.long 0x5040100,0x5040504,0x1000100,0x1000100,0x5040504,0x5040504,0x0,0x0
.long 0x5040504,0x5040504,0x1000100,0x1000100,0x5040100,0x5040504,0x0,0x0
.long 0x5040100,0x5040504,0x1000100,0x1000100,0x5040504,0x5040504,0x0,0x0
.long 0x5040504,0x5040504,0x1000100,0x1000100,0x5040100,0x5040504,0x0,0x0
.long 0x5040100,0x5040504,0x1000100,0x1000100,0x5040504,0x5040504,0x0,0x0
.long 0x5040504,0x5040504,0x1000100,0x1000100,0x5040100,0x5040504,0x0,0x0
.long 0x5040100,0x5040504,0x1000100,0x1000100,0x5040504,0x5040504,0x0,0x0
.p2align 7
P3_TAB:
.long 0x80003f80,0x80003f80,0x80003f80,0x80003f80,0x80003f80,0xbec43f6d,0xbf353f35,0xbf6d3ec4
.long 0x80003f80,0xbf353f35,0xbf80248d,0xbf35bf35,0x80003f80,0xbf6d3ec4,0xbf35bf35,0x3ec4bf6d
.long 0x80003f80,0xbf80248d,0xa50dbf80,0x3f80a554,0x80003f80,0xbf6dbec4,0x3f35bf35,0x3ec43f6d
.long 0x80003f80,0xbf35bf35,0x3f80a554,0xbf353f35,0x80003f80,0xbec4bf6d,0x3f353f35,0xbf6dbec4
.long 0x80003f80,0xa50dbf80,0x258d3f80,0xa5d4bf80,0x80003f80,0x3ec4bf6d,0xbf353f35,0x3f6dbec4
.long 0x80003f80,0x3f35bf35,0xbf8025b0,0x3f353f35,0x80003f80,0x3f6dbec4,0xbf35bf35,0xbec43f6d
.long 0x80003f80,0x3f80a554,0xa5d4bf80,0xbf80261f,0x80003f80,0x3f6d3ec4,0x3f35bf35,0xbec4bf6d
.long 0x80003f80,0x3f353f35,0x3f80a5f7,0x3f35bf35,0x80003f80,0x3ec43f6d,0x3f353f35,0x3f6d3ec4
.long 0x3f80,0x3f80,0x3f80,0x3f80,0xbec43f6d,0xbf353f35,0xbf6d3ec4,0xbf80a554
.long 0xbf353f35,0xbf80a5f7,0xbf35bf35,0x25d4bf80,0xbf6d3ec4,0xbf35bf35,0x3ec4bf6d,0x3f80261f
.long 0xbf80a742,0x2677bf80,0x3f80a68d,0xa6543f80,0xbf6dbec4,0x3f35bf35,0x3ec43f6d,0xbf80a742
.long 0xbf35bf35,0x3f80a60d,0xbf353f35,0x269fbf80,0xbec4bf6d,0x3f353f35,0xbf6dbec4,0x3f80a60d
.long 0x27c2bf80,0xa6f73f80,0xa70dbf80,0xa6d43f80,0x3ec4bf6d,0xbf353f35,0x3f6dbec4,0xbf80a777
.long 0x3f35bf35,0xbf80a78d,0x3f353f35,0x27c2bf80,0x3f6dbec4,0xbf35bf35,0xbec43f6d,0x3f802804
.long 0x3f80268d,0xa68dbf80,0xbf80a796,0xa71f3f80,0x3f6d3ec4,0x3f35bf35,0xbec4bf6d,0xbf802754
.long 0x3f353f35,0x3f802816,0x3f35bf35,0xa68dbf80,0x3ec43f6d,0x3f353f35,0x3f6d3ec4,0x3f802889
.long 0x80003f80,0x80003f80,0x80003f80,0x80003f80,0xbf80248d,0xbf6dbec4,0xbf35bf35,0xbec4bf6d
.long 0xa50dbf80,0x3f35bf35,0x3f80a554,0x3f353f35,0x3f80a554,0x3ec43f6d,0xbf353f35,0xbf6dbec4
.long 0x258d3f80,0xbf8025b0,0xa5d4bf80,0x3f80a5f7,0xbf8025b0,0x3ec4bf6d,0x3f353f35,0xbf6d3ec4
.long 0xa5d4bf80,0x3f353f35,0xbf80261f,0x3f35bf35,0x3f80a5f7,0xbf6d3ec4,0x3f35bf35,0xbec43f6d
.long 0x260d3f80,0xa630bf80,0x26543f80,0xa677bf80,0xbf80261f,0x3f6d3ec4,0xbf35bf35,0x3ec43f6d
.long 0xa630bf80,0xbf353f35,0x3f80a742,0xbf35bf35,0x3f80a731,0xbec4bf6d,0xbf353f35,0x3f6d3ec4
.long 0x26543f80,0x3f80a742,0xa69fbf80,0xbf80a60d,0xbf80a68d,0xbec43f6d,0x3f353f35,0x3f6dbec4
.long 0xa677bf80,0xbf35bf35,0xbf80a60d,0xbf353f35,0x3f80a742,0x3f6dbec4,0x3f35bf35,0x3ec4bf6d
.long 0x3f80,0x3f80,0x3f80,0x3f80,0xbf6dbec4,0xbf35bf35,0xbec4bf6d,0x250dbf80
.long 0x3f35bf35,0x3f8025b0,0x3f353f35,0xa58d3f80,0x3ec43f6d,0xbf353f35,0xbf6dbec4,0x25d4bf80
.long 0xbf80a731,0x2630bf80,0x3f80261f,0xa60d3f80,0x3ec4bf6d,0x3f353f35,0xbf6d3ec4,0x2630bf80
.long 0x3f353f35,0xbf80a742,0x3f35bf35,0xa6543f80,0xbf6d3ec4,0x3f35bf35,0xbec43f6d,0x2677bf80
.long 0x27b1bf80,0xa6b03f80,0x269fbf80,0xa68d3f80,0x3f6d3ec4,0xbf35bf35,0x3ec43f6d,0x269fbf80
.long 0xbf353f35,0x3f80a58e,0xbf35bf35,0xa6b03f80,0xbec4bf6d,0xbf353f35,0x3f6d3ec4,0x27b1bf80
.long 0x3f80258d,0x27c2bf80,0xbf80a777,0xa6d43f80,0xbec43f6d,0x3f353f35,0x3f6dbec4,0xa70dbf80
.long 0xbf35bf35,0xbf80a78d,0xbf353f35,0xa6f73f80,0x3f6dbec4,0x3f35bf35,0x3ec4bf6d,0x27c2bf80
.long 0x3f800000,0x3f800000,0x3f800000,0x3f800000,0x3f800000,0x3f6d3ec4,0x3f353f35,0x3ec43f6d
.long 0x3f800000,0x3f353f35,0x248d3f80,0xbf353f35,0x3f800000,0x3ec43f6d,0xbf353f35,0xbf6dbec4
.long 0x3f800000,0x248d3f80,0xbf80250d,0xa554bf80,0x3f800000,0xbec43f6d,0xbf35bf35,0x3f6dbec4
.long 0x3f800000,0xbf353f35,0xa554bf80,0x3f353f35,0x3f800000,0xbf6d3ec4,0x3f35bf35,0xbec43f6d
.long 0x3f800000,0xbf80250d,0x3f80a58d,0xbf8025d4,0x3f800000,0xbf6dbec4,0x3f353f35,0xbec4bf6d
.long 0x3f800000,0xbf35bf35,0x25b03f80,0x3f35bf35,0x3f800000,0xbec4bf6d,0xbf353f35,0x3f6d3ec4
.long 0x3f800000,0xa554bf80,0xbf8025d4,0x261f3f80,0x3f800000,0x3ec4bf6d,0xbf35bf35,0xbf6d3ec4
.long 0x3f800000,0x3f35bf35,0xa5f7bf80,0xbf35bf35,0x3f800000,0x3f6dbec4,0x3f35bf35,0x3ec4bf6d
.long 0xbf800000,0xbf800000,0xbf800000,0xbf800000,0xbf6dbec4,0xbf35bf35,0xbec4bf6d,0x2554bf80
.long 0xbf35bf35,0x25f7bf80,0x3f35bf35,0x3f8025d4,0xbec4bf6d,0x3f35bf35,0x3f6d3ec4,0xa61f3f80
.long 0x2742bf80,0x3f802677,0x268d3f80,0xbf80a654,0x3ec4bf6d,0x3f353f35,0xbf6d3ec4,0x2742bf80
.long 0x3f35bf35,0x260d3f80,0xbf35bf35,0x3f80269f,0x3f6dbec4,0xbf353f35,0x3ec4bf6d,0x260d3f80
.long 0x3f8027c2,0xbf80a6f7,0x3f80a70d,0xbf80a6d4,0x3f6d3ec4,0xbf35bf35,0x3ec43f6d,0x2777bf80
.long 0x3f353f35,0x278dbf80,0xbf353f35,0x3f8027c2,0x3ec43f6d,0x3f35bf35,0xbf6dbec4,0xa8043f80
.long 0xa68d3f80,0x3f80a68d,0x2796bf80,0xbf80a71f,0xbec43f6d,0x3f353f35,0x3f6dbec4,0xa754bf80
.long 0xbf353f35,0xa8163f80,0x3f353f35,0x3f80a68d,0xbf6d3ec4,0xbf353f35,0xbec43f6d,0xa8893f80
.long 0x3f800000,0x3f800000,0x3f800000,0x3f800000,0x248d3f80,0xbec43f6d,0xbf353f35,0xbf6d3ec4
.long 0xbf80250d,0xbf35bf35,0xa554bf80,0x3f35bf35,0xa554bf80,0x3f6dbec4,0x3f353f35,0xbec43f6d
.long 0x3f80a58d,0x25b03f80,0xbf8025d4,0xa5f7bf80,0x25b03f80,0xbf6dbec4,0x3f35bf35,0x3ec43f6d
.long 0xbf8025d4,0x3f35bf35,0x261f3f80,0xbf35bf35,0xa5f7bf80,0x3ec43f6d,0xbf35bf35,0x3f6d3ec4
.long 0x3f80a60d,0xbf802630,0x3f80a654,0xbf802677,0x261f3f80,0x3ec4bf6d,0xbf353f35,0x3f6dbec4
.long 0xbf802630,0x3f353f35,0xa742bf80,0xbf353f35,0xa731bf80,0xbf6d3ec4,0x3f353f35,0x3ec4bf6d
.long 0x3f80a654,0xa742bf80,0xbf80269f,0xa60d3f80,0xa68d3f80,0x3f6d3ec4,0x3f35bf35,0xbec4bf6d
.long 0xbf802677,0xbf353f35,0xa60d3f80,0x3f353f35,0xa742bf80,0xbec4bf6d,0xbf35bf35,0xbf6dbec4
.long 0xbf800000,0xbf800000,0xbf800000,0xbf800000,0x3ec4bf6d,0x3f35bf35,0x3f6dbec4,0x3f80250d
.long 0x3f353f35,0xa5b03f80,0xbf353f35,0xbf80a58d,0xbf6d3ec4,0xbf35bf35,0x3ec4bf6d,0x3f8025d4
.long 0x2731bf80,0x3f802630,0xa61f3f80,0xbf80a60d,0x3f6d3ec4,0xbf353f35,0xbec4bf6d,0x3f802630
.long 0xbf353f35,0x2742bf80,0x3f353f35,0xbf80a654,0xbec4bf6d,0x3f353f35,0xbf6dbec4,0x3f802677
.long 0x3f8027b1,0xbf80a6b0,0x3f80269f,0xbf80a68d,0xbec43f6d,0x3f35bf35,0xbf6d3ec4,0x3f80269f
.long 0xbf35bf35,0x258e3f80,0x3f35bf35,0xbf80a6b0,0x3f6dbec4,0xbf35bf35,0xbec43f6d,0x3f8027b1
.long 0xa58d3f80,0x3f8027c2,0x2777bf80,0xbf80a6d4,0xbf6dbec4,0xbf353f35,0x3ec43f6d,0x3f80a70d
.long 0x3f35bf35,0x278dbf80,0xbf35bf35,0xbf80a6f7,0x3ec43f6d,0x3f353f35,0x3f6d3ec4,0x3f8027c2
.long 0x0,0x3f80,0x3f80,0x3f80,0x0,0xbec43f6c,0xbf353f35,0xbf6c3ec4
.long 0x0,0xbf353f35,0xbf80248d,0xbf35bf35,0x0,0xbf6c3ec4,0xbf35bf35,0x3ec4bf6c
.long 0x0,0xbf80248d,0xa50dbf80,0x3f80a554,0x0,0xbf6cbec4,0x3f35bf35,0x3ec43f6c
.long 0x0,0xbf35bf35,0x3f80a554,0xbf353f35,0x0,0xbec4bf6c,0x3f353f35,0xbf6cbec4
.long 0x0,0xa50dbf80,0x258d3f80,0xa5d4bf80,0x0,0x3ec4bf6c,0xbf353f35,0x3f6cbec4
.long 0x0,0x3f35bf35,0xbf8025b1,0x3f353f35,0x0,0x3f6cbec4,0xbf35bf35,0xbec43f6c
.long 0x0,0x3f80a554,0xa5d4bf80,0xbf80261f,0x0,0x3f6c3ec4,0x3f35bf35,0xbec4bf6c
.long 0x0,0x3f353f35,0x3f80a5f7,0x3f35bf35,0x0,0x3ec43f6c,0x3f353f35,0x3f6c3ec4
.long 0xbf80,0xbf80,0xbf80,0xbf80,0x3ec4bf6d,0x3f35bf35,0x3f6dbec4,0x3f802554
.long 0x3f35bf35,0x3f8025f7,0x3f353f35,0xa5d43f80,0x3f6dbec4,0x3f353f35,0xbec43f6d,0xbf80a61f
.long 0x3f802742,0xa6773f80,0xbf80268d,0x2654bf80,0x3f6d3ec4,0xbf353f35,0xbec4bf6d,0x3f802742
.long 0x3f353f35,0xbf80260d,0x3f35bf35,0xa69f3f80,0x3ec43f6d,0xbf35bf35,0x3f6d3ec4,0xbf80260d
.long 0xa7c23f80,0x26f7bf80,0x270d3f80,0x26d4bf80,0xbec43f6d,0x3f35bf35,0xbf6d3ec4,0x3f802777
.long 0xbf353f35,0x3f80278d,0xbf35bf35,0xa7c23f80,0xbf6d3ec4,0x3f353f35,0x3ec4bf6d,0xbf80a804
.long 0xbf80a68d,0x268d3f80,0x3f802796,0x271fbf80,0xbf6dbec4,0xbf353f35,0x3ec43f6d,0x3f80a754
.long 0xbf35bf35,0xbf80a816,0xbf353f35,0x268d3f80,0xbec4bf6d,0xbf35bf35,0xbf6dbec4,0xbf80a889
.long 0x3f80,0x3f80,0x3f80,0x3f80,0xbf80248d,0xbf6cbec4,0xbf35bf35,0xbec4bf6c
.long 0xa50dbf80,0x3f35bf35,0x3f80a554,0x3f353f35,0x3f80a554,0x3ec43f6c,0xbf353f35,0xbf6cbec4
.long 0x258d3f80,0xbf8025b1,0xa5d4bf80,0x3f80a5f7,0xbf8025b1,0x3ec4bf6c,0x3f353f35,0xbf6c3ec4
.long 0xa5d4bf80,0x3f353f35,0xbf80261f,0x3f35bf35,0x3f80a5f7,0xbf6c3ec4,0x3f35bf35,0xbec43f6c
.long 0x260d3f80,0xa631bf80,0x26543f80,0xa677bf80,0xbf80261f,0x3f6c3ec4,0xbf35bf35,0x3ec43f6c
.long 0xa631bf80,0xbf353f35,0x3f80a742,0xbf35bf35,0x3f80a730,0xbec4bf6c,0xbf353f35,0x3f6c3ec4
.long 0x26543f80,0x3f80a742,0xa69fbf80,0xbf80a60e,0xbf80a68e,0xbec43f6c,0x3f353f35,0x3f6cbec4
.long 0xa677bf80,0xbf35bf35,0xbf80a60e,0xbf353f35,0x3f80a742,0x3f6cbec4,0x3f35bf35,0x3ec4bf6c
.long 0xbf80,0xbf80,0xbf80,0xbf80,0x3f6d3ec4,0x3f353f35,0x3ec43f6d,0xa50d3f80
.long 0xbf353f35,0xbf80a5b0,0xbf35bf35,0x258dbf80,0xbec4bf6d,0x3f35bf35,0x3f6d3ec4,0xa5d43f80
.long 0x3f802731,0xa6303f80,0xbf80a61f,0x260dbf80,0xbec43f6d,0xbf35bf35,0x3f6dbec4,0xa6303f80
.long 0xbf35bf35,0x3f802742,0xbf353f35,0x2654bf80,0x3f6dbec4,0xbf353f35,0x3ec4bf6d,0xa6773f80
.long 0xa7b13f80,0x26b0bf80,0xa69f3f80,0x268dbf80,0xbf6dbec4,0x3f353f35,0xbec4bf6d,0xa69f3f80
.long 0x3f35bf35,0xbf80258e,0x3f353f35,0x26b0bf80,0x3ec43f6d,0x3f35bf35,0xbf6dbec4,0xa7b13f80
.long 0xbf80a58d,0xa7c23f80,0x3f802777,0x26d4bf80,0x3ec4bf6d,0xbf35bf35,0xbf6d3ec4,0x270d3f80
.long 0x3f353f35,0x3f80278d,0x3f35bf35,0x26f7bf80,0xbf6d3ec4,0xbf353f35,0xbec43f6d,0xa7c23f80
.long 0xbf800000,0xbf800000,0xbf800000,0xbf800000,0xbf800000,0xbf6dbec4,0xbf35bf35,0xbec4bf6d
.long 0xbf800000,0xbf35bf35,0xa48dbf80,0x3f35bf35,0xbf800000,0xbec4bf6d,0x3f35bf35,0x3f6d3ec4
.long 0xbf800000,0xa48dbf80,0x3f80a50d,0x25543f80,0xbf800000,0x3ec4bf6d,0x3f353f35,0xbf6d3ec4
.long 0xbf800000,0x3f35bf35,0x25543f80,0xbf35bf35,0xbf800000,0x3f6dbec4,0xbf353f35,0x3ec4bf6d
.long 0xbf800000,0x3f80a50d,0xbf80258d,0x3f80a5d4,0xbf800000,0x3f6d3ec4,0xbf35bf35,0x3ec43f6d
.long 0xbf800000,0x3f353f35,0xa5b0bf80,0xbf353f35,0xbf800000,0x3ec43f6d,0x3f35bf35,0xbf6dbec4
.long 0xbf800000,0x25543f80,0x3f80a5d4,0xa61fbf80,0xbf800000,0xbec43f6d,0x3f353f35,0x3f6dbec4
.long 0xbf800000,0xbf353f35,0x25f73f80,0x3f353f35,0xbf800000,0xbf6d3ec4,0xbf353f35,0xbec43f6d
.long 0x3f804000,0x3f804000,0x3f804000,0x3f804000,0x3f094016,0xbecf4018,0xbfa44002,0xbffb3fb2
.long 0xbd6f4024,0xbfed3fe2,0xc024bd6f,0xbfe2bfed,0xbf3a4026,0xc02b3ea2,0xbfa8c016,0x3fd5c007
.long 0xbfb5401b,0xc01bbfb5,0x3fb5c01b,0x401b3fb5,0xc0034002,0xbf8cc02b,0x40393bf1,0xbf8e402a
.long 0xc0243fbc,0x3f44c036,0x3fbc4024,0xc036bf44,0xc0393f46,0x4018bfe9,0xbfbf4026,0x3ec8c03e
.long 0xc040a7be,0x404026c2,0xc0402739,0x40402631,0xc039bf46,0x40183fe9,0xbfbfc026,0x3ec8403e
.long 0xc024bfbc,0x3f444036,0x3fbcc024,0xc0363f44,0xc003c002,0xbf8c402b,0x4039bbf1,0xbf8ec02a
.long 0xbfb5c01b,0xc01b3fb5,0x3fb5401b,0x401bbfb5,0xbf3ac026,0xc02bbea2,0xbfa84016,0x3fd54007
.long 0xbd6fc024,0xbfedbfe2,0xc0243d6f,0xbfe23fed,0x3f09c016,0xbecfc018,0xbfa4c002,0xbffbbfb2
.long 0xbf800000,0xbf800000,0xbf800000,0xbf800000,0xa48dbf80,0x3ec4bf6d,0x3f35bf35,0x3f6dbec4
.long 0x3f80a50d,0x3f353f35,0x25543f80,0xbf353f35,0x25543f80,0xbf6d3ec4,0xbf35bf35,0x3ec4bf6d
.long 0xbf80258d,0xa5b0bf80,0x3f80a5d4,0x25f73f80,0xa5b0bf80,0x3f6d3ec4,0xbf353f35,0xbec4bf6d
.long 0x3f80a5d4,0xbf353f35,0xa61fbf80,0x3f353f35,0x25f73f80,0xbec4bf6d,0x3f353f35,0xbf6dbec4
.long 0xbf80260d,0x3f80a630,0xbf802654,0x3f80a677,0xa61fbf80,0xbec43f6d,0x3f35bf35,0xbf6d3ec4
.long 0x3f80a630,0xbf35bf35,0x27423f80,0x3f35bf35,0x27313f80,0x3f6dbec4,0xbf35bf35,0xbec43f6d
.long 0xbf802654,0x27423f80,0x3f80a69f,0x260dbf80,0x268dbf80,0xbf6dbec4,0xbf353f35,0x3ec43f6d
.long 0x3f80a677,0x3f35bf35,0x260dbf80,0xbf35bf35,0x27423f80,0x3ec43f6d,0x3f353f35,0x3f6d3ec4
.long 0x3f804000,0x3f804000,0x3f804000,0x3f804000,0xc0163f09,0xc018becf,0xc002bfa4,0xbfb2bffb
.long 0x3d6fc024,0x3fedbfe2,0x40243d6f,0x3fe23fed,0x40263f3a,0x3ea2402b,0xc0163fa8,0xc007bfd5
.long 0xbfb5401b,0xc01bbfb5,0x3fb5c01b,0x401b3fb5,0xc002c003,0x402bbf8c,0xbbf14039,0xc02abf8e
.long 0x4024bfbc,0xbf444036,0xbfbcc024,0x40363f44,0x3f464039,0xbfe9c018,0x40263fbf,0xc03ebec8
.long 0xc040a789,0x4040a785,0xc040a75d,0x4040a79f,0x3f46c039,0xbfe94018,0x4026bfbf,0xc03e3ec8
.long 0x40243fbc,0xbf44c036,0xbfbc4024,0x4036bf44,0xc0024003,0x402b3f8c,0xbbf1c039,0xc02a3f8e
.long 0xbfb5c01b,0xc01b3fb5,0x3fb5401b,0x401bbfb5,0x4026bf3a,0x3ea2c02b,0xc016bfa8,0xc0073fd5
.long 0x3d6f4024,0x3fed3fe2,0x4024bd6f,0x3fe2bfed,0xc016bf09,0xc0183ecf,0xc0023fa4,0xbfb23ffb
.long 0x3f800000,0x3f800000,0x3f800000,0x3f800000,0x3f800000,0x3f7ffb11,0x3f7fec43,0x3f7fd397
.long 0x3f800000,0x3f7fec43,0x3f7fb10f,0x3f7f4e6d,0x3f800000,0x3f7fd397,0x3f7f4e6d,0x3f7e70b0
.long 0x3f800000,0x3f7fb10f,0x3f7ec46d,0x3f7d3aac,0x3f800000,0x3f7f84ab,0x3f7e1324,0x3f7baccd
.long 0x3f800000,0x3f7f4e6d,0x3f7d3aac,0x3f79c79d,0x3f800000,0x3f7f0e58,0x3f7c3b28,0x3f778bc5
.long 0x3f800000,0x3f7ec46d,0x3f7b14be,0x3f74fa0b,0x3f800000,0x3f7e70b0,0x3f79c79d,0x3f721352
.long 0x3f800000,0x3f7e1324,0x3f7853f8,0x3f6ed89e,0x3f800000,0x3f7dabcc,0x3f76ba07,0x3f6b4b0c
.long 0x3f800000,0x3f7d3aac,0x3f74fa0b,0x3f676bd8,0x3f800000,0x3f7cbfc9,0x3f731447,0x3f633c5a
.long 0x3f800000,0x3f7c3b28,0x3f710908,0x3f5ebe05,0x3f800000,0x3f7baccd,0x3f6ed89e,0x3f59f26a
.long 0x3f800000,0x3f800000,0x3f800000,0x3f800000,0x3f7fb10f,0x3f7f84ab,0x3f7f4e6d,0x3f7f0e58
.long 0x3f7ec46d,0x3f7e1324,0x3f7d3aac,0x3f7c3b28,0x3f7d3aac,0x3f7baccd,0x3f79c79d,0x3f778bc5
.long 0x3f7b14be,0x3f7853f8,0x3f74fa0b,0x3f710908,0x3f7853f8,0x3f740bdd,0x3f6ed89e,0x3f68bf3c
.long 0x3f74fa0b,0x3f6ed89e,0x3f676bd8,0x3f5ebe05,0x3f710908,0x3f68bf3c,0x3f5ebe05,0x3f531849
.long 0x3f6c835e,0x3f61c598,0x3f54db31,0x3f45e403,0x3f676bd8,0x3f59f26a,0x3f49d112,0x3f373a23
.long 0x3f61c598,0x3f514d3d,0x3f3daef9,0x3f273656,0x3f5b941a,0x3f47de65,0x3f3085bb,0x3f15f6d9
.long 0x3f54db31,0x3f3daef9,0x3f226799,0x3f039c3d,0x3f4d9f02,0x3f32c8c9,0x3f13682a,0x3ee0924f
.long 0x3f45e403,0x3f273656,0x3f039c3d,0x3eb8442a,0x3f3daef9,0x3f1b02c6,0x3ee63375,0x3e8e9a22
.long 0x3f800000,0x3f800000,0x3f800000,0x3f800000,0x3f7ec46d,0x3f7e70b0,0x3f7e1324,0x3f7dabcc
.long 0x3f7b14be,0x3f79c79d,0x3f7853f8,0x3f76ba07,0x3f74fa0b,0x3f721352,0x3f6ed89e,0x3f6b4b0c
.long 0x3f6c835e,0x3f676bd8,0x3f61c598,0x3f5b941a,0x3f61c598,0x3f59f26a,0x3f514d3d,0x3f47de65
.long 0x3f54db31,0x3f49d112,0x3f3daef9,0x3f3085bb,0x3f45e403,0x3f373a23,0x3f273656,0x3f15f6d9
.long 0x3f3504f3,0x3f226799,0x3f0e39da,0x3ef15aea,0x3f226799,0x3f0b9a6b,0x3ee63375,0x3eb263ef
.long 0x3f0e39da,0x3ee63375,0x3eac7cd4,0x3e605c13,0x3ef15aea,0x3eb263ef,0x3e605c13,0x3dafb680
.long 0x3ec3ef15,0x3e78cfcc,0x3dc8bd36,0xbd48fb30,0x3e94a031,0x3e09cf86,0xbcc90ab0,0xbe3b6ecf
.long 0x3e47c5c2,0x3cc90ab0,0xbe164083,0xbea09ae5,0x3dc8bd36,0xbdafb680,0xbe888e93,0xbee0924f
.long 0x3f800000,0x3f800000,0x3f800000,0x3f800000,0x3f7d3aac,0x3f7cbfc9,0x3f7c3b28,0x3f7baccd
.long 0x3f74fa0b,0x3f731447,0x3f710908,0x3f6ed89e,0x3f676bd8,0x3f633c5a,0x3f5ebe05,0x3f59f26a
.long 0x3f54db31,0x3f4d9f02,0x3f45e403,0x3f3daef9,0x3f3daef9,0x3f32c8c9,0x3f273656,0x3f1b02c6
.long 0x3f226799,0x3f13682a,0x3f039c3d,0x3ee63375,0x3f039c3d,0x3ee0924f,0x3eb8442a,0x3e8e9a22
.long 0x3ec3ef15,0x3e94a031,0x3e47c5c2,0x3dc8bd36,0x3e78cfcc,0x3e09cf86,0x3cc90ab0,0xbdafb680
.long 0x3dc8bd36,0xbcc90ab0,0xbe164083,0xbe888e93,0xbd48fb30,0xbe3b6ecf,0xbea09ae5,0xbee0924f
.long 0xbe47c5c2,0xbeac7cd4,0xbef15aea,0xbf187fc0,0xbeac7cd4,0xbef6e0cb,0xbf1d7fd1,0xbf3b8f3b
.long 0xbef15aea,0xbf1d7fd1,0xbf3daef9,0xbf584853,0xbf187fc0,0xbf3b8f3b,0xbf584853,0xbf6db293
.long 0x0,0x0,0x0,0x0,0x0,0x3c490e90,0x3cc90ab0,0x3d16c32c
.long 0x0,0x3cc90ab0,0x3d48fb30,0x3d96a905,0x0,0x3d16c32c,0x3d96a905,0x3de1bc2e
.long 0x0,0x3d48fb30,0x3dc8bd36,0x3e164083,0x0,0x3d7b2b74,0x3dfab273,0x3e3b6ecf
.long 0x0,0x3d96a905,0x3e164083,0x3e605c13,0x0,0x3dafb680,0x3e2f10a2,0x3e827dc0
.long 0x0,0x3dc8bd36,0x3e47c5c2,0x3e94a031,0x0,0x3de1bc2e,0x3e605c13,0x3ea68f12
.long 0x0,0x3dfab273,0x3e78cfcc,0x3eb8442a,0x0,0x3e09cf86,0x3e888e93,0x3ec9b953
.long 0x0,0x3e164083,0x3e94a031,0x3edae880,0x0,0x3e22abb6,0x3ea09ae5,0x3eebcbbb
.long 0x0,0x3e2f10a2,0x3eac7cd4,0x3efc5d27,0x0,0x3e3b6ecf,0x3eb8442a,0x3f064b82
.long 0x0,0x0,0x0,0x0,0x3d48fb30,0x3d7b2b74,0x3d96a905,0x3dafb680
.long 0x3dc8bd36,0x3dfab273,0x3e164083,0x3e2f10a2,0x3e164083,0x3e3b6ecf,0x3e605c13,0x3e827dc0
.long 0x3e47c5c2,0x3e78cfcc,0x3e94a031,0x3eac7cd4,0x3e78cfcc,0x3e9aa086,0x3eb8442a,0x3ed53641
.long 0x3e94a031,0x3eb8442a,0x3edae880,0x3efc5d27,0x3eac7cd4,0x3ed53641,0x3efc5d27,0x3f10d3cd
.long 0x3ec3ef15,0x3ef15aea,0x3f0e39da,0x3f226799,0x3edae880,0x3f064b82,0x3f1d7fd1,0x3f32c8c9
.long 0x3ef15aea,0x3f13682a,0x3f2beb4a,0x3f41d870,0x3f039c3d,0x3f1ff6cb,0x3f396842,0x3f4f7a1f
.long 0x3f0e39da,0x3f2beb4a,0x3f45e403,0x3f5b941a,0x3f187fc0,0x3f373a23,0x3f514d3d,0x3f660f88
.long 0x3f226799,0x3f41d870,0x3f5b941a,0x3f6ed89e,0x3f2beb4a,0x3f4bbbf8,0x3f64aa59,0x3f75dec6
.long 0x0,0x0,0x0,0x0,0x3dc8bd36,0x3de1bc2e,0x3dfab273,0x3e09cf86
.long 0x3e47c5c2,0x3e605c13,0x3e78cfcc,0x3e888e93,0x3e94a031,0x3ea68f12,0x3eb8442a,0x3ec9b953
.long 0x3ec3ef15,0x3edae880,0x3ef15aea,0x3f039c3d,0x3ef15aea,0x3f064b82,0x3f13682a,0x3f1ff6cb
.long 0x3f0e39da,0x3f1d7fd1,0x3f2beb4a,0x3f396842,0x3f226799,0x3f32c8c9,0x3f41d870,0x3f4f7a1f
.long 0x3f3504f3,0x3f45e403,0x3f54db31,0x3f61c598,0x3f45e403,0x3f5695e5,0x3f64aa59,0x3f6ff573
.long 0x3f54db31,0x3f64aa59,0x3f710908,0x3f79c79d,0x3f61c598,0x3f6ff573,0x3f79c79d,0x3f7f0e58
.long 0x3f6c835e,0x3f7853f8,0x3f7ec46d,0x3f7fb10f,0x3f74fa0b,0x3f7dabcc,0x3f7fec43,0x3f7baccd
.long 0x3f7b14be,0x3f7fec43,0x3f7d3aac,0x3f731447,0x3f7ec46d,0x3f7f0e58,0x3f76ba07,0x3f660f88
.long 0x0,0x0,0x0,0x0,0x3e164083,0x3e22abb6,0x3e2f10a2,0x3e3b6ecf
.long 0x3e94a031,0x3ea09ae5,0x3eac7cd4,0x3eb8442a,0x3edae880,0x3eebcbbb,0x3efc5d27,0x3f064b82
.long 0x3f0e39da,0x3f187fc0,0x3f226799,0x3f2beb4a,0x3f2beb4a,0x3f373a23,0x3f41d870,0x3f4bbbf8
.long 0x3f45e403,0x3f514d3d,0x3f5b941a,0x3f64aa59,0x3f5b941a,0x3f660f88,0x3f6ed89e,0x3f75dec6
.long 0x3f6c835e,0x3f74fa0b,0x3f7b14be,0x3f7ec46d,0x3f7853f8,0x3f7dabcc,0x3f7fec43,0x3f7f0e58
.long 0x3f7ec46d,0x3f7fec43,0x3f7d3aac,0x3f76ba07,0x3f7fb10f,0x3f7baccd,0x3f731447,0x3f660f88
.long 0x3f7b14be,0x3f710908,0x3f61c598,0x3f4d9f02,0x3f710908,0x3f604621,0x3f49d112,0x3f2e3bde
.long 0x3f61c598,0x3f49d112,0x3f2beb4a,0x3f08f59b,0x3f4d9f02,0x3f2e3bde,0x3f08f59b,0x3ebe1d4a
.long 0x35803580,0x80003600,0x80003600,0x80003600,0xb5803580,0xb4c835fb,0xb54435ed,0xb58e35d5
.long 0x35803580,0xb54435ed,0xb5b535b5,0xb5ed3544,0xb5803580,0xb58e35d5,0xb5ed3544,0xb5fbb4c8
.long 0x35803580,0xb5b535b5,0xb6001b0d,0xb5b5b5b5,0xb5803580,0xb5d5358e,0xb5edb544,0xb4c8b5fb
.long 0x35803580,0xb5ed3544,0xb5b5b5b5,0x3544b5ed,0xb5803580,0xb5fb34c8,0xb544b5ed,0x35d5b58e
.long 0x35803580,0xb6001b0d,0x9b8db600,0x36009bd4,0xb5803580,0xb5fbb4c8,0x3544b5ed,0x35d5358e
.long 0x35803580,0xb5edb544,0x35b5b5b5,0x354435ed,0xb5803580,0xb5d5b58e,0x35edb544,0xb4c835fb
.long 0x35803580,0xb5b5b5b5,0x36009bd4,0xb5b535b5,0xb5803580,0xb58eb5d5,0x35ed3544,0xb5fb34c8
.long 0x35803580,0xb544b5ed,0x35b535b5,0xb5edb544,0xb5803580,0xb4c8b5fb,0x354435ed,0xb58eb5d5
.long 0x80003600,0x80003600,0x80003600,0x80003600,0xb5b535b5,0xb5d5358e,0xb5ed3544,0xb5fb34c8
.long 0xb6001b0d,0xb5edb544,0xb5b5b5b5,0xb544b5ed,0xb5b5b5b5,0xb4c8b5fb,0x3544b5ed,0x35d5b58e
.long 0x9b8db600,0x35b5b5b5,0x36009bd4,0x35b535b5,0x35b5b5b5,0x35fb34c8,0x354435ed,0xb58e35d5
.long 0x36009bd4,0x354435ed,0xb5b535b5,0xb5edb544,0x35b535b5,0xb58e35d5,0xb5edb544,0x34c8b5fb
.long 0x1c0d3600,0xb6001c30,0x9c54b600,0x36009c77,0xb5b535b5,0xb58eb5d5,0x35edb544,0x34c835fb
.long 0xb6001c30,0x3544b5ed,0x35b535b5,0xb5ed3544,0xb5b5b5b5,0x35fbb4c8,0xb54435ed,0xb58eb5d5
.long 0x9c54b600,0x35b535b5,0xb6001c9f,0x35b5b5b5,0x35b5b5b5,0xb4c835fb,0xb544b5ed,0x35d5358e
.long 0x36009c77,0xb5ed3544,0x35b5b5b5,0xb54435ed,0x35b535b5,0xb5d5b58e,0x35ed3544,0xb5fbb4c8
.long 0x80003600,0x80003600,0x80003600,0x80003600,0xb6001b0d,0xb5fbb4c8,0xb5edb544,0xb5d5b58e
.long 0x9b8db600,0x3544b5ed,0x35b5b5b5,0x35edb544,0x36009bd4,0x35d5358e,0x354435ed,0xb4c835fb
.long 0x1c0d3600,0xb5b535b5,0xb6001c30,0xb5b5b5b5,0xb6001c30,0xb58eb5d5,0x3544b5ed,0x35fbb4c8
.long 0x9c54b600,0x35edb544,0x35b535b5,0xb54435ed,0x36009c77,0x34c835fb,0xb5ed3544,0xb58eb5d5
.long 0x1c8d3600,0xb6001c9f,0x9cb0b600,0x36009db1,0xb6001c9f,0x34c8b5fb,0x35ed3544,0xb58e35d5
.long 0x9cb0b600,0x35ed3544,0xb5b535b5,0xb544b5ed,0x36009db1,0xb58e35d5,0xb544b5ed,0x35fb34c8
.long 0x1cd43600,0xb5b5b5b5,0x36009dc2,0xb5b535b5,0xb6009d0d,0x35d5b58e,0xb54435ed,0xb4c8b5fb
.long 0x9cf7b600,0x354435ed,0xb5b5b5b5,0x35ed3544,0x36009dc2,0xb5fb34c8,0x35edb544,0xb5d5358e
.long 0x80003600,0x80003600,0x80003600,0x80003600,0xb5b5b5b5,0xb58eb5d5,0xb544b5ed,0xb4c8b5fb
.long 0x36009bd4,0x35ed3544,0x35b535b5,0x354435ed,0xb5b535b5,0xb5fb34c8,0xb5edb544,0xb58eb5d5
.long 0x9c54b600,0x35b5b5b5,0x36009c77,0x35b535b5,0x35b535b5,0xb4c835fb,0xb5ed3544,0xb5d5b58e
.long 0xb6001c9f,0xb544b5ed,0x35b5b5b5,0x35ed3544,0x35b5b5b5,0x35d5358e,0xb54435ed,0xb5fbb4c8
.long 0x1cd43600,0xb6009d0d,0x9cf7b600,0x36009dc2,0xb5b5b5b5,0x35d5b58e,0x354435ed,0xb5fb34c8
.long 0x36009dc2,0xb54435ed,0xb5b5b5b5,0x35edb544,0xb5b535b5,0xb4c8b5fb,0x35ed3544,0xb5d5358e
.long 0x9d1fb600,0x35b535b5,0xb6009c8d,0x35b5b5b5,0x35b535b5,0xb5fbb4c8,0x35edb544,0xb58e35d5
.long 0xb6009c8d,0x35edb544,0xb5b535b5,0x3544b5ed,0x35b5b5b5,0xb58e35d5,0x3544b5ed,0xb4c835fb
.long 0x35803580,0x9b8db600,0x1c0d3600,0x9c54b600,0xb5803580,0x34c8b5fb,0xb54435ed,0x358eb5d5
.long 0x35803580,0x3544b5ed,0xb5b535b5,0x35edb544,0xb5803580,0x358eb5d5,0xb5ed3544,0x35fb34c8
.long 0x35803580,0x35b5b5b5,0xb6001c30,0x35b535b5,0xb5803580,0x35d5b58e,0xb5edb544,0x34c835fb
.long 0x35803580,0x35edb544,0xb5b5b5b5,0xb54435ed,0xb5803580,0x35fbb4c8,0xb544b5ed,0xb5d5358e
.long 0x35803580,0x36009bd4,0x9c54b600,0xb6001c9f,0xb5803580,0x35fb34c8,0x3544b5ed,0xb5d5b58e
.long 0x35803580,0x35ed3544,0x35b5b5b5,0xb544b5ed,0xb5803580,0x35d5358e,0x35edb544,0x34c8b5fb
.long 0x35803580,0x35b535b5,0x36009c77,0x35b5b5b5,0xb5803580,0x358e35d5,0x35ed3544,0x35fbb4c8
.long 0x35803580,0x354435ed,0x35b535b5,0x35ed3544,0xb5803580,0x34c835fb,0x354435ed,0x358e35d5
.long 0x1c8d3600,0x9cb0b600,0x1cd43600,0x9cf7b600,0xb5b535b5,0x35d5b58e,0xb5ed3544,0x35fbb4c8
.long 0xb6001c9f,0x35ed3544,0xb5b5b5b5,0x354435ed,0xb5b5b5b5,0x34c835fb,0x3544b5ed,0xb5d5358e
.long 0x9cb0b600,0xb5b535b5,0x36009dc2,0xb5b5b5b5,0x35b5b5b5,0xb5fbb4c8,0x354435ed,0x358eb5d5
.long 0x36009db1,0xb544b5ed,0xb5b535b5,0x35ed3544,0x35b535b5,0x358eb5d5,0xb5edb544,0xb4c835fb
.long 0x1cd43600,0x36009dc2,0x9d1fb600,0xb6009c8d,0xb5b535b5,0x358e35d5,0x35edb544,0xb4c8b5fb
.long 0xb6009d0d,0xb54435ed,0x35b535b5,0x35edb544,0xb5b5b5b5,0xb5fb34c8,0xb54435ed,0x358e35d5
.long 0x9cf7b600,0xb5b5b5b5,0xb6009c8d,0xb5b535b5,0x35b5b5b5,0x34c8b5fb,0xb544b5ed,0xb5d5b58e
.long 0x36009dc2,0x35edb544,0x35b5b5b5,0x3544b5ed,0x35b535b5,0x35d5358e,0x35ed3544,0x35fb34c8
.long 0x1d0d3600,0x9d1fb600,0x1d303600,0x9e31b600,0xb6009cd4,0x35fb34c8,0xb5edb544,0x35d5358e
.long 0x9d1fb600,0xb54435ed,0x35b5b5b5,0xb5ed3544,0x36009dd4,0xb5d5b58e,0x354435ed,0x34c8b5fb
.long 0x1d303600,0x35b5b5b5,0xb6009c0e,0x35b535b5,0xb6009c8d,0x358e35d5,0x3544b5ed,0xb5fb34c8
.long 0x9e31b600,0xb5ed3544,0x35b535b5,0x3544b5ed,0x36009de5,0xb4c8b5fb,0xb5ed3544,0x358e35d5
.long 0x1d543600,0x36009df7,0x9e42b600,0xb6001c0d,0xb6009c0e,0xb4c835fb,0x35ed3544,0x358eb5d5
.long 0x1d8db600,0xb5edb544,0xb5b535b5,0x354435ed,0x36009df7,0x358eb5d5,0xb544b5ed,0xb5fbb4c8
.long 0x1d773600,0x35b535b5,0x36009e0d,0x35b5b5b5,0xb60097b7,0xb5d5358e,0xb54435ed,0x34c835fb
.long 0x9e42b600,0xb544b5ed,0xb5b5b5b5,0xb5edb544,0x36009e04,0x35fbb4c8,0x35edb544,0x35d5b58e
.long 0x1d543600,0x1d8db600,0x1d773600,0x9e42b600,0xb5b5b5b5,0x358e35d5,0xb544b5ed,0x34c835fb
.long 0x36009df7,0xb5edb544,0x35b535b5,0xb544b5ed,0xb5b535b5,0x35fbb4c8,0xb5edb544,0x358e35d5
.long 0x9e42b600,0xb5b535b5,0x36009e0d,0xb5b5b5b5,0x35b535b5,0x34c8b5fb,0xb5ed3544,0x35d5358e
.long 0xb6001e84,0x354435ed,0x35b5b5b5,0xb5edb544,0x35b5b5b5,0xb5d5b58e,0xb54435ed,0x35fb34c8
.long 0x1d9f3600,0x36009e16,0x1d0db600,0xb6001d0d,0xb5b5b5b5,0xb5d5358e,0x354435ed,0x35fbb4c8
.long 0x36001dd4,0x3544b5ed,0xb5b5b5b5,0xb5ed3544,0xb5b535b5,0x34c835fb,0x35ed3544,0x35d5b58e
.long 0x1d0db600,0xb5b5b5b5,0xb6001e96,0xb5b535b5,0x35b535b5,0x35fb34c8,0x35edb544,0x358eb5d5
.long 0xb6001f09,0xb5ed3544,0xb5b535b5,0xb54435ed,0x35b5b5b5,0x358eb5d5,0x3544b5ed,0x34c8b5fb
TAB_END:
```
